```python
import torch

def _softmax(x, axis=-1):
    return torch.softmax(x, dim=axis)
def _gelu(x):
    return torch.nn.functional.gelu(x, approximate="tanh")
def _silu(x):
    return torch.nn.functional.silu(x)
def _sigmoid(x):
    return torch.sigmoid(x)
def _layernorm(x, axis=-1, eps=1e-5):
    m = x.mean(dim=axis, keepdim=True)
    v = x.var(dim=axis, keepdim=True, unbiased=False)
    return (x - m) / torch.sqrt(v + eps)
def _scatter_add(tgt, idx, src, axis=0):
    return tgt.clone().index_add_(axis, idx, src)
def _segment_sum(src, seg, n):
    out = torch.zeros((n,) + src.shape[1:], dtype=src.dtype)
    return out.index_add_(0, seg, src)
def _pad(x, pw):
    flat = tuple(v for pair in reversed(pw) for v in pair)
    return torch.nn.functional.pad(x, flat)

kernel_name = 'gated_mix__sliding_block__sliding_block__prompt'

def setup_inputs():

    _w = (lambda a: (lambda t: t.to(torch.bfloat16) if t.is_floating_point() else t)(torch.as_tensor(a)))
    def _A_setup():
        B, S, D = 1, 2048, 512
        return {
            "x": _w((lambda *s: torch.randn(*s, dtype=torch.bfloat16) * 0.05)(B, S, D)),
            "wqkv": _w((lambda *s: torch.randn(*s, dtype=torch.bfloat16) * 1.6)(D, 3 * D)),
            "wo": _w((lambda *s: torch.randn(*s, dtype=torch.bfloat16) * 0.05)(D, D)),
        }
    _A_in = _A_setup()

    def _B_setup():
        B, S, D = 1, 2048, 512
        return {
            "x": _w((lambda *s: torch.randn(*s, dtype=torch.bfloat16) * 0.05)(B, S, D)),
            "wqkv": _w((lambda *s: torch.randn(*s, dtype=torch.bfloat16) * 1.6)(D, 3 * D)),
            "wo": _w((lambda *s: torch.randn(*s, dtype=torch.bfloat16) * 0.05)(D, D)),
        }
    _B_in = _B_setup()

    return {
        "A_x": _A_in["x"],
        "A_wqkv": _A_in["wqkv"],
        "A_wo": _A_in["wo"],
        "B_x": _B_in["x"],
        "B_wqkv": _B_in["wqkv"],
        "B_wo": _B_in["wo"],
        "gate_w": _w((lambda *s: torch.randn(*s, dtype=torch.bfloat16) * 0.05)(512) * 16.0),
    }

def reference(A_x, A_wqkv, A_wo, B_x, B_wqkv, B_wo, gate_w):
    def _A_ref(x, wqkv, wo):
        B, S, D = x.shape
        H = 32; Dh = D // H; W = 256
        qkv = (lambda x, *d: x.permute(*d))((x @ wqkv).reshape(B, S, 3, H, Dh), 2, 0, 3, 1, 4)
        q, k, v = qkv[0], qkv[1], qkv[2]
        scores = torch.einsum("bhqd,bhkd->bhqk", q, k) * (Dh ** -0.5)
        idx = torch.arange(S)
        mask = (idx[:, None] - idx[None, :] >= 0) & (idx[:, None] - idx[None, :] < W)
        scores = torch.where(mask[None, None], scores, -1e9)
        p = _softmax(scores, axis=-1)
        o = torch.einsum("bhqk,bhkd->bhqd", p, v)
        return (lambda x, *d: x.permute(*d))(o, 0, 2, 1, 3).reshape(B, S, D) @ wo

    def _B_ref(x, wqkv, wo):
        B, S, D = x.shape
        H = 32; Dh = D // H; W = 256
        qkv = (lambda x, *d: x.permute(*d))((x @ wqkv).reshape(B, S, 3, H, Dh), 2, 0, 3, 1, 4)
        q, k, v = qkv[0], qkv[1], qkv[2]
        scores = torch.einsum("bhqd,bhkd->bhqk", q, k) * (Dh ** -0.5)
        idx = torch.arange(S)
        mask = (idx[:, None] - idx[None, :] >= 0) & (idx[:, None] - idx[None, :] < W)
        scores = torch.where(mask[None, None], scores, -1e9)
        p = _softmax(scores, axis=-1)
        o = torch.einsum("bhqk,bhkd->bhqd", p, v)
        return (lambda x, *d: x.permute(*d))(o, 0, 2, 1, 3).reshape(B, S, D) @ wo

    x = A_x
    g = _sigmoid((x * gate_w).sum(-1, keepdims=True))
    a = _A_ref(x, A_wqkv, A_wo)
    b = _B_ref(x, B_wqkv, B_wo)
    return g * a + (1 - g) * b
```

```asm
; @launch grid=(256,1,1) block=(256,1,1) lds=163840
.amdgcn_target "amdgcn-amd-amdhsa--gfx950"
.text
.p2align 12
.globl gated_mix__sliding_block__sliding_block__prompt_kernel
.p2align 8
.type gated_mix__sliding_block__sliding_block__prompt_kernel,@function
gated_mix__sliding_block__sliding_block__prompt_kernel:
    s_cmp_ge_u32 s2, 256
    s_cbranch_scc1 L_end
    s_load_dwordx4 s[4:7], s[0:1], 0
    s_load_dwordx2 s[8:9], s[0:1], 16
    s_load_dwordx4 s[12:15], s[0:1], 32
    s_load_dwordx4 s[16:19], s[0:1], 48
    s_load_dwordx4 s[20:23], s[0:1], 64
    s_getpc_b64 s[92:93]
L_pc:
    v_lshlrev_b32 v58, 7, v0
    v_min_u32 v58, L_code_end-L_main-4, v58
    v_add_u32 v58, L_main-L_pc, v58
    global_load_dword v59, v58, s[92:93]
    v_lshrrev_b32 v19, 6, v0
    v_and_b32 v0, 63, v0
    v_readfirstlane_b32 s68, v19
    s_and_b32 s76, s2, 7
    s_lshr_b32 s77, s2, 3
    s_lshr_b32 s78, s76, 2
    s_lshl_b32 s78, s78, 3
    s_and_b32 s79, s77, 7
    s_or_b32 s64, s78, s79
    s_and_b32 s78, s76, 3
    s_lshl_b32 s78, s78, 2
    s_lshr_b32 s79, s77, 3
    s_or_b32 s65, s78, s79
    s_lshr_b32 s66, s65, 3
    s_and_b32 s67, s65, 7
    s_lshl_b32 s78, s76, 2
    s_or_b32 s90, s78, s79
    s_and_b32 s91, s77, 7
    s_lshr_b32 s89, s90, 1
    s_and_b32 s70, s68, 1
    s_lshr_b32 s69, s68, 1
    s_lshl_b32 s71, s68, 12
    v_lshrrev_b32 v19, 3, v0
    v_and_b32 v20, 7, v0
    v_lshrrev_b32 v21, 4, v0
    v_xor_b32 v22, v20, v21
    v_lshlrev_b32 v22, 4, v22
    v_lshl_add_u32 v2, v19, 10, v22
    v_xor_b32 v22, 64, v22
    v_lshl_add_u32 v23, v19, 10, v22
    v_add_u32 v3, 7168, v23
    v_add_u32 v4, 14336, v2
    v_add_u32 v5, 21504, v23
    s_and_b32 s76, s65, 3
    s_lshl_b32 s76, s76, 1
    s_add_u32 s98, s64, s76
    s_and_b32 s98, s98, 7
    s_lshl_b32 s77, s64, 17
    s_lshl_b32 s76, s68, 15
    s_add_u32 s77, s77, s76
    v_add_u32 v2, s77, v2
    v_add_u32 v3, s77, v3
    v_add_u32 v4, s77, v4
    v_add_u32 v5, s77, v5
    s_lshl_b32 s72, s98, 7
    v_and_b32 v21, 1, v21
    v_lshlrev_b32 v21, 2, v21
    v_xor_b32 v21, v20, v21
    v_lshlrev_b32 v21, 4, v21
    v_mul_u32_u24 v22, 3072, v19
    v_add_u32 v6, v21, v22
    v_add_u32 v7, 23552, v6
    v_add_u32 v8, 47104, v6
    v_add_u32 v9, 70656, v6
    s_mul_i32 s76, s70, 98304
    s_lshl_b32 s77, s67, 7
    s_add_u32 s76, s76, s77
    v_add_u32 v6, s76, v6
    v_add_u32 v7, s76, v7
    v_add_u32 v8, s76, v8
    v_add_u32 v9, s76, v9
    s_add_u32 s101, s69, 1
    s_lshl_b32 s101, s101, 10
    s_mul_i32 s73, s98, 196608
    s_add_u32 s73, s73, s101
    s_mov_b32 s99, s98
    s_add_u32 s100, s98, s69
    s_waitcnt lgkmcnt(0)
    s_mov_b32 s24, s4
    s_mov_b32 s25, s5
    s_mov_b32 s26, 0x200000
    s_mov_b32 s27, 0x20000
    s_cmp_eq_u32 s66, 0
    s_cselect_b32 s28, s6, s12
    s_cselect_b32 s29, s7, s13
    s_mov_b32 s30, 0x180000
    s_mov_b32 s31, 0x20000
    s_cmp_lt_u32 s67, 4
    s_cbranch_scc0 L_nq_1
    s_lshr_b32 s76, s2, 3
    s_lshl_b32 s76, s76, 2
    s_add_u32 s76, s76, s68
    s_mul_i32 s76, s76, 12288
    s_add_u32 s92, s28, s76
    s_addc_u32 s93, s29, 0
    s_load_dword s75, s[92:93], 384
    s_load_dword s75, s[92:93], 448
    s_load_dword s75, s[92:93], 3456
    s_load_dword s75, s[92:93], 3520
    s_load_dword s75, s[92:93], 6528
    s_load_dword s75, s[92:93], 6592
    s_load_dword s75, s[92:93], 9600
    s_load_dword s75, s[92:93], 9664
L_nq_1:
    s_add_u32 m0, s71, 0x0
    s_nop 0
    buffer_load_dwordx4 v2, s[24:27], s72 offen offset:0 lds
    buffer_load_dwordx4 v3, s[24:27], s72 offen offset:1024 lds
    s_mov_b32 s32, s22
    s_mov_b32 s33, s23
    s_mov_b32 s34, 0x1400000
    s_mov_b32 s35, 0x20000
    s_lshl_b32 s76, s65, 2
    s_lshl_b32 s77, s70, 1
    s_add_u32 s76, s76, s77
    s_lshl_b32 s77, s64, 2
    s_add_u32 s77, s77, s69
    s_lshl_b32 s78, s76, 16
    s_lshl_b32 s79, s77, 10
    s_add_u32 s78, s78, s79
    s_load_dword s75, s[32:33], s78
    s_add_u32 s78, s78, 65536
    s_load_dword s75, s[32:33], s78
    s_mul_i32 s78, s76, 73728
    s_mul_i32 s79, s77, 1152
    s_add_u32 s78, s78, s79
    s_add_u32 s78, s78, 0x400000
    s_load_dword s75, s[32:33], s78
    s_add_u32 s78, s78, 73728
    s_load_dword s75, s[32:33], s78
    s_lshl_b32 s78, s77, 16
    s_lshl_b32 s79, s76, 10
    s_add_u32 s78, s78, s79
    s_add_u32 s78, s78, 0x900000
    s_load_dword s75, s[32:33], s78
    s_lshl_b32 s92, s69, 1
    s_sub_u32 s92, 3, s92
    s_lshl_b32 s92, s92, 16
    s_add_u32 s78, s78, s92
    s_load_dword s75, s[32:33], s78
    s_lshl_b32 s78, s65, 4
    s_add_u32 s78, s78, s64
    s_mul_i32 s78, s78, 384
    s_add_u32 s78, s78, 0xd10000
    s_load_dword s75, s[32:33], s78
    v_mov_b32 v19, 0xd30000
    buffer_load_dword v30, v19, s[32:35], 0 offen sc1
    v_lshlrev_b32 v1, 4, v0
    v_and_b32 v19, 31, v0
    v_lshrrev_b32 v20, 5, v0
    v_bfe_u32 v21, v0, 1, 3
    s_lshl_b32 s76, s69, 12
    s_sub_u32 s77, 3, s69
    s_lshl_b32 s77, s77, 12
    v_lshlrev_b32 v22, 7, v19
    v_or_b32 v23, 0, v20
    v_xor_b32 v23, v23, v21
    v_lshl_add_u32 v23, v23, 4, v22
    v_add_u32 v10, s76, v23
    v_add_u32 v14, s77, v23
    v_or_b32 v23, 2, v20
    v_xor_b32 v23, v23, v21
    v_lshl_add_u32 v23, v23, 4, v22
    v_add_u32 v11, s76, v23
    v_add_u32 v15, s77, v23
    buffer_load_dwordx4 v4, s[24:27], s72 offen offset:2048 lds
    v_or_b32 v23, 4, v20
    v_xor_b32 v23, v23, v21
    v_lshl_add_u32 v23, v23, 4, v22
    v_add_u32 v12, s76, v23
    v_add_u32 v16, s77, v23
    v_or_b32 v23, 6, v20
    v_xor_b32 v23, v23, v21
    v_lshl_add_u32 v23, v23, 4, v22
    v_add_u32 v13, s76, v23
    v_add_u32 v17, s77, v23
    v_bfe_u32 v19, v0, 2, 2
    v_and_b32 v21, 3, v0
    v_lshl_add_u32 v22, v20, 3, v19
    v_lshlrev_b32 v22, 7, v22
    v_bfe_u32 v23, v0, 4, 1
    v_lshlrev_b32 v23, 1, v23
    v_lshrrev_b32 v31, 1, v21
    v_add_u32 v23, v23, v31
    buffer_load_dwordx4 v5, s[24:27], s72 offen offset:3072 lds
    s_add_u32 m0, s71, 0x4000
    s_add_u32 s99, s99, 1
    s_and_b32 s99, s99, 7
    s_lshl_b32 s76, s70, 2
    v_add_u32 v23, s76, v23
    v_lshrrev_b32 v19, 1, v19
    v_lshlrev_b32 v19, 2, v19
    v_xor_b32 v23, v23, v19
    v_lshl_add_u32 v22, v23, 4, v22
    v_and_b32 v21, 1, v21
    v_lshl_add_u32 v18, v21, 3, v22
    s_mov_b32 s56, s16
    s_mov_b32 s57, s17
    s_mov_b32 s58, 0x400
    s_mov_b32 s59, 0x20000
    s_mov_b32 s60, s20
    s_mov_b32 s61, s21
    s_mov_b32 s62, 0x100
    s_mov_b32 s63, 0x20000
    s_mov_b32 s44, s8
    s_mov_b32 s45, s9
    s_lshl_b32 s72, s99, 7
    buffer_load_dwordx4 v6, s[28:31], s73 offen offset:0 lds
    s_mov_b32 s46, 0x80000
    s_mov_b32 s47, 0x20000
    s_mov_b32 s48, s14
    s_mov_b32 s49, s15
    s_mov_b32 s50, 0x80000
    s_mov_b32 s51, 0x20000
    s_mov_b32 s52, s18
    s_mov_b32 s53, s19
    s_mov_b32 s54, 0x200000
    s_mov_b32 s55, 0x20000
    s_mov_b32 s36, s22
    s_mov_b32 s37, s23
    s_mov_b32 s38, 0x1400000
    s_mov_b32 s39, 0x20000
    s_mov_b32 s40, s22
    s_mov_b32 s41, s23
    s_mov_b32 s42, 0x1400000
    s_mov_b32 s43, 0x20000
    buffer_load_dwordx4 v7, s[28:31], s73 offen offset:1024 lds
    s_cmp_ge_u32 s64, 1
    s_cselect_b32 s38, s38, 0
    s_cmp_ge_u32 s64, 2
    s_cselect_b32 s42, s42, 0
    v_lshrrev_b32 v20, 5, v0
    s_lshl_b32 s86, s65, 2
    s_lshl_b32 s76, s70, 1
    s_add_u32 s86, s86, s76
    s_lshl_b32 s87, s64, 2
    s_add_u32 s76, s87, s69
    s_add_u32 s77, s87, 3
    s_sub_u32 s77, s77, s69
    s_lshl_b32 s78, s86, 16
    s_lshl_b32 s79, s76, 10
    s_add_u32 s80, s78, s79
    s_add_u32 s81, s80, 65536
    s_lshl_b32 s79, s77, 10
    s_add_u32 s82, s78, s79
    s_add_u32 s83, s82, 65536
    s_mul_i32 s78, s86, 73728
    buffer_load_dwordx4 v8, s[28:31], s73 offen offset:2048 lds
    s_add_u32 s78, s78, 0x400000
    s_mul_i32 s79, s76, 1152
    s_add_u32 s84, s78, s79
    s_mul_i32 s79, s77, 1152
    s_add_u32 s85, s78, s79
    v_bfe_u32 v19, v0, 4, 1
    v_and_b32 v21, 15, v0
    v_lshlrev_b32 v22, 8, v20
    v_lshl_add_u32 v22, v21, 4, v22
    v_mul_u32_u24 v23, 73728, v19
    v_add_u32 v28, v22, v23
    s_lshl_b32 s78, s70, 3
    s_add_u32 s76, s78, s69
    s_add_u32 s77, s78, 3
    s_sub_u32 s77, s77, s69
    v_mul_u32_u24 v23, 4160, v19
    v_add_u32 v22, v22, v23
    s_lshl_b32 s79, s76, 10
    buffer_load_dwordx4 v9, s[28:31], s73 offen offset:3072 lds
    s_add_u32 m0, s71, 0x8000
    s_mul_i32 s73, s99, 196608
    s_add_u32 s73, s73, s101
    v_add_u32 v24, s79, v1
    s_mul_i32 s79, s76, 1040
    s_add_u32 s79, s79, 16384
    v_add_u32 v26, s79, v22
    s_lshl_b32 s79, s77, 10
    v_add_u32 v25, s79, v1
    s_mul_i32 s79, s77, 1040
    s_add_u32 s79, s79, 16384
    v_add_u32 v27, s79, v22
    v_bfe_u32 v19, v0, 3, 1
    v_bfe_u32 v21, v0, 4, 1
    s_lshl_b32 s76, s69, 1
    s_sub_u32 s76, 3, s76
    v_mul_i32_i24 v21, s76, v21
    v_add_u32 v21, s69, v21
    v_mul_u32_u24 v21, 1152, v21
    v_mul_u32_u24 v19, 73728, v19
    v_add_u32 v21, v21, v19
    buffer_load_dwordx4 v2, s[24:27], s72 offen offset:0 lds
    v_and_b32 v19, 7, v0
    v_lshl_add_u32 v21, v19, 4, v21
    v_add_u32 v29, 1024, v21
    s_mul_i32 s76, s86, 73728
    s_mul_i32 s77, s87, 1152
    s_add_u32 s76, s76, s77
    s_add_u32 s3, s76, 0x400000
    s_lshl_b32 s76, s65, 4
    s_add_u32 s76, s76, s64
    s_mul_i32 s88, s76, 384
    s_add_u32 s88, s88, 0xd10000
    s_lshl_b32 s76, s86, 16
    s_lshl_b32 s77, s87, 10
    s_add_u32 s76, s76, s77
    s_sub_u32 s12, s76, 8192
    s_sub_u32 s13, s76, 4096
    s_sub_u32 s14, s3, 9216
    s_sub_u32 s15, s3, 4608
    buffer_load_dwordx4 v3, s[24:27], s72 offen offset:1024 lds
    s_add_u32 s20, s12, 65536
    s_add_u32 s21, s13, 65536
    s_add_u32 s22, s14, 73728
    s_add_u32 s23, s15, 73728
    s_add_u32 s76, s87, s69
    s_add_u32 s77, s87, 3
    s_sub_u32 s77, s77, s69
    s_lshl_b32 s78, s86, 10
    s_add_u32 s78, s78, 0x900000
    s_lshl_b32 s76, s76, 16
    s_lshl_b32 s77, s77, 16
    s_add_u32 s16, s76, s78
    s_add_u32 s17, s77, s78
    s_add_u32 s18, s16, 1024
    s_add_u32 s19, s17, 1024
    s_lshl_b32 s76, s68, 2
    s_add_u32 s76, s76, s88
    v_mov_b32 v20, s76
    buffer_load_dwordx4 v4, s[24:27], s72 offen offset:2048 lds
    v_mov_b32 v21, 0x7f000000
    v_cmp_eq_u32 vcc, 0, v0
    s_nop 1
    v_cndmask_b32 v31, v21, v20, vcc
    s_lshl_b32 s76, s70, 13
    v_add_u32 v162, s76, v1
    v_and_b32 v20, 15, v0
    v_lshrrev_b32 v21, 5, v0
    v_lshlrev_b32 v21, 8, v21
    v_lshl_add_u32 v20, v20, 4, v21
    v_bfe_u32 v21, v0, 4, 1
    v_cmp_eq_u32 vcc, 0, v21
    s_mul_i32 s76, s70, 8320
    s_add_u32 s76, s76, 16384
    v_mov_b32 v22, 1024
    v_add_u32 v23, 512, v20
    v_cndmask_b32 v160, v22, v20, vcc
    v_cndmask_b32 v161, v22, v23, vcc
    v_add_u32 v163, s76, v160
    buffer_load_dwordx4 v5, s[24:27], s72 offen offset:3072 lds
    s_add_u32 m0, s71, 0xc000
    s_add_u32 s99, s99, 1
    s_and_b32 s99, s99, 7
    v_add_u32 v164, s76, v161
    v_mov_b32 v165, 0x2b800000
    v_mov_b32 v166, 0x71800000
    v_mov_b32 v167, 0x3800000
    v_mov_b32 v168, 0x7e800000
    s_lshl_b32 s76, s70, 2
    s_add_u32 s76, s76, s88
    v_and_b32 v20, 1, v0
    v_bfe_u32 v21, v0, 1, 1
    v_add_u32 v22, 1, v20
    v_mul_u32_u24 v22, 384, v22
    v_lshlrev_b32 v21, 3, v21
    v_add_u32 v21, s76, v21
    v_sub_u32 v21, v21, v22
    v_lshrrev_b32 v22, 2, v0
    v_lshlrev_b32 v22, 4, v22
    v_add_u32 v20, v20, v22
    v_cmp_gt_u32 vcc, s64, v20
    s_lshl_b32 s72, s99, 7
    buffer_load_dwordx4 v6, s[28:31], s73 offen offset:0 lds
    v_mov_b32 v22, 0x7f000000
    v_mov_b32 v23, 0
    v_cndmask_b32 v169, v22, v21, vcc
    v_cndmask_b32 v170, v23, -1, vcc
    v_lshrrev_b32 v20, 3, v0
    v_and_b32 v21, 7, v0
    v_bfe_u32 v22, v0, 4, 1
    v_lshlrev_b32 v22, 2, v22
    v_xor_b32 v22, v21, v22
    v_lshlrev_b32 v22, 4, v22
    v_lshl_add_u32 v172, v20, 10, v22
    v_add_u32 v173, 7168, v172
    v_add_u32 v174, 14336, v172
    v_add_u32 v175, 21504, v172
    s_lshl_b32 s11, s68, 15
    s_lshl_b32 s79, s91, 7
    s_add_u32 s11, s11, s79
    s_lshl_b32 s79, s90, 1
    buffer_load_dwordx4 v7, s[28:31], s73 offen offset:1024 lds
    s_add_u32 s79, s79, s69
    s_and_b32 s76, s79, 3
    s_lshr_b32 s77, s76, 1
    s_xor_b32 s76, s76, s77
    s_and_b32 s76, s76, 1
    v_and_b32 v20, 7, v0
    s_lshl_b32 s77, s70, 3
    v_add_u32 v20, s77, v20
    v_lshlrev_b32 v20, 4, v20
    v_add_u32 v20, s89, v20
    v_mul_u32_u24 v20, 384, v20
    v_bfe_u32 v21, v0, 3, 1
    s_lshl_b32 s76, s76, 1
    v_add_u32 v21, s76, v21
    v_lshl_add_u32 v20, v21, 2, v20
    v_add_u32 v20, 0xd10080, v20
    v_cmp_gt_u32 vcc, 16, v0
    v_mov_b32 v21, 0x7f000000
    buffer_load_dwordx4 v8, s[28:31], s73 offen offset:2048 lds
    v_mov_b32 v22, 0
    v_cndmask_b32 v171, v21, v20, vcc
    v_cndmask_b32 v176, v22, -1, vcc
    s_lshl_b32 s89, s79, 16
    s_lshl_b32 s76, s70, 15
    s_add_u32 s89, s89, s76
    s_add_u32 s89, s89, 0x900000
    s_mov_b32 s90, s79
    buffer_load_dwordx4 v9, s[28:31], s73 offen offset:3072 lds
    s_mov_b64 exec, 0
    s_cmp_eq_u32 s68, 0
    s_cbranch_scc1 L_stubhead_0
    s_cmp_eq_u32 s68, 1
    s_cbranch_scc1 L_stubhead_1
    s_cmp_eq_u32 s68, 2
    s_cbranch_scc1 L_stubhead_2
    s_branch L_stubhead_3
L_warm_back:
    s_mov_b64 exec, -1
    s_waitcnt vmcnt(14)
    v_add_u32 v19, 1, v30
    v_max_u32 v19, 1, v19
    s_or_b32 s92, s2, s68
    v_or_b32 v20, s92, v0
    v_cmp_eq_u32 vcc, 0, v20
    v_mov_b32 v21, 0x7f000000
    v_mov_b32 v22, 0xd30000
    v_cndmask_b32 v22, v21, v22, vcc
    v_cndmask_b32 v23, v21, v20, vcc
    buffer_store_dword v19, v22, s[32:35], 0 offen sc1
    buffer_store_dword v19, v23, s[60:63], 0 offen sc1
    s_branch L_main
.p2align 12
L_main:
L_stubhead_0:
L_stub_0:
    s_cbranch_execz L_stub_4
    s_waitcnt vmcnt(10)
    s_barrier
    ds_read_b128 a[0:3], v10 offset:0
    ds_read_b64_tr_b16 v[32:33], v18 offset:16384
    ds_read_b64_tr_b16 v[34:35], v18 offset:16896
    ds_read_b128 a[4:7], v14 offset:0
    ds_read_b64_tr_b16 v[36:37], v18 offset:24576
    ds_read_b64_tr_b16 v[38:39], v18 offset:25088
    ds_read_b128 a[8:11], v11 offset:0
    ds_read_b64_tr_b16 v[40:41], v18 offset:18432
    ds_read_b64_tr_b16 v[42:43], v18 offset:18944
    ds_read_b128 a[12:15], v15 offset:0
    ds_read_b64_tr_b16 v[44:45], v18 offset:26624
    ds_read_b64_tr_b16 v[46:47], v18 offset:27136
    s_waitcnt lgkmcnt(9)
    v_mfma_f32_32x32x16_bf16 v[96:111], v[32:35], a[0:3], 0
    ds_read_b128 a[16:19], v12 offset:0
    ds_read_b64_tr_b16 v[48:49], v18 offset:20480
    ds_read_b64_tr_b16 v[50:51], v18 offset:20992
    s_waitcnt lgkmcnt(11)
    v_mfma_f32_32x32x16_bf16 v[112:127], v[32:35], a[4:7], 0
    ds_read_b128 a[20:23], v16 offset:0
    ds_read_b64_tr_b16 v[52:53], v18 offset:28672
    ds_read_b64_tr_b16 v[54:55], v18 offset:29184
    s_waitcnt lgkmcnt(12)
    v_mfma_f32_32x32x16_bf16 v[128:143], a[0:3], v[36:39], 0
    s_add_u32 m0, s71, 0x10000
    s_mul_i32 s73, s99, 196608
    s_add_u32 s73, s73, s101
    buffer_load_dwordx4 v2, s[24:27], s72 offen offset:0 lds
    buffer_load_dwordx4 v3, s[24:27], s72 offen offset:1024 lds
    v_mfma_f32_32x32x16_bf16 v[144:159], a[4:7], v[36:39], 0
    buffer_load_dwordx4 v4, s[24:27], s72 offen offset:2048 lds
    buffer_load_dwordx4 v5, s[24:27], s72 offen offset:3072 lds
    s_add_u32 m0, s71, 0x14000
    s_add_u32 s99, s99, 1
    s_and_b32 s99, s99, 7
    s_lshl_b32 s72, s99, 7
    s_waitcnt lgkmcnt(6)
    v_mfma_f32_32x32x16_bf16 v[96:111], v[40:43], a[8:11], v[96:111]
    ds_read_b128 a[24:27], v13 offset:0
    ds_read_b64_tr_b16 v[32:33], v18 offset:22528
    ds_read_b64_tr_b16 v[34:35], v18 offset:23040
    v_mfma_f32_32x32x16_bf16 v[112:127], v[40:43], a[12:15], v[112:127]
    ds_read_b128 a[28:31], v17 offset:0
    ds_read_b64_tr_b16 v[36:37], v18 offset:30720
    ds_read_b64_tr_b16 v[38:39], v18 offset:31232
    v_mfma_f32_32x32x16_bf16 v[128:143], a[8:11], v[44:47], v[128:143]
    buffer_load_dwordx4 v6, s[28:31], s73 offen offset:0 lds
    buffer_load_dwordx4 v7, s[28:31], s73 offen offset:1024 lds
    v_mfma_f32_32x32x16_bf16 v[144:159], a[12:15], v[44:47], v[144:159]
    buffer_load_dwordx4 v8, s[28:31], s73 offen offset:2048 lds
    buffer_load_dwordx4 v9, s[28:31], s73 offen offset:3072 lds
    s_add_u32 m0, s71, 0x18000
    s_mul_i32 s73, s99, 196608
    s_add_u32 s73, s73, s101
    s_waitcnt lgkmcnt(6)
    s_waitcnt vmcnt(10)
    s_barrier
    v_mfma_f32_32x32x16_bf16 v[96:111], v[48:51], a[16:19], v[96:111]
    ds_read_b128 a[32:35], v10 offset:32768
    ds_read_b64_tr_b16 v[40:41], v18 offset:49152
    ds_read_b64_tr_b16 v[42:43], v18 offset:49664
    v_mfma_f32_32x32x16_bf16 v[112:127], v[48:51], a[20:23], v[112:127]
    ds_read_b128 a[36:39], v14 offset:32768
    ds_read_b64_tr_b16 v[44:45], v18 offset:57344
    ds_read_b64_tr_b16 v[46:47], v18 offset:57856
    v_mfma_f32_32x32x16_bf16 v[128:143], a[16:19], v[52:55], v[128:143]
    buffer_load_dwordx4 v2, s[24:27], s72 offen offset:0 lds
    buffer_load_dwordx4 v3, s[24:27], s72 offen offset:1024 lds
    v_mfma_f32_32x32x16_bf16 v[144:159], a[20:23], v[52:55], v[144:159]
    buffer_load_dwordx4 v4, s[24:27], s72 offen offset:2048 lds
    buffer_load_dwordx4 v5, s[24:27], s72 offen offset:3072 lds
    s_add_u32 m0, s71, 0x1c000
    s_add_u32 s99, s99, 1
    s_and_b32 s99, s99, 7
    s_lshl_b32 s72, s99, 7
    s_waitcnt lgkmcnt(6)
    v_mfma_f32_32x32x16_bf16 v[96:111], v[32:35], a[24:27], v[96:111]
    ds_read_b128 a[40:43], v11 offset:32768
    ds_read_b64_tr_b16 v[48:49], v18 offset:51200
    ds_read_b64_tr_b16 v[50:51], v18 offset:51712
    v_mfma_f32_32x32x16_bf16 v[112:127], v[32:35], a[28:31], v[112:127]
    ds_read_b128 a[44:47], v15 offset:32768
    ds_read_b64_tr_b16 v[52:53], v18 offset:59392
    ds_read_b64_tr_b16 v[54:55], v18 offset:59904
    v_mfma_f32_32x32x16_bf16 v[128:143], a[24:27], v[36:39], v[128:143]
    buffer_load_dwordx4 v6, s[28:31], s73 offen offset:0 lds
    buffer_load_dwordx4 v7, s[28:31], s73 offen offset:1024 lds
    v_mfma_f32_32x32x16_bf16 v[144:159], a[28:31], v[36:39], v[144:159]
    buffer_load_dwordx4 v8, s[28:31], s73 offen offset:2048 lds
    buffer_load_dwordx4 v9, s[28:31], s73 offen offset:3072 lds
    s_waitcnt lgkmcnt(6)
    v_mfma_f32_32x32x16_bf16 v[96:111], v[40:43], a[32:35], v[96:111]
    ds_read_b128 a[48:51], v12 offset:32768
    ds_read_b64_tr_b16 v[32:33], v18 offset:53248
    ds_read_b64_tr_b16 v[34:35], v18 offset:53760
    v_mfma_f32_32x32x16_bf16 v[112:127], v[40:43], a[36:39], v[112:127]
    ds_read_b128 a[52:55], v16 offset:32768
    ds_read_b64_tr_b16 v[36:37], v18 offset:61440
    ds_read_b64_tr_b16 v[38:39], v18 offset:61952
    v_mfma_f32_32x32x16_bf16 v[128:143], a[32:35], v[44:47], v[128:143]
    s_add_u32 m0, s71, 0x20000
    s_mul_i32 s73, s99, 196608
    s_add_u32 s73, s73, s101
    buffer_load_dwordx4 v2, s[24:27], s72 offen offset:0 lds
    v_mfma_f32_32x32x16_bf16 v[144:159], a[36:39], v[44:47], v[144:159]
    buffer_load_dwordx4 v3, s[24:27], s72 offen offset:1024 lds
    s_waitcnt lgkmcnt(6)
    v_mfma_f32_32x32x16_bf16 v[96:111], v[48:51], a[40:43], v[96:111]
    ds_read_b128 a[56:59], v13 offset:32768
    ds_read_b64_tr_b16 v[40:41], v18 offset:55296
    ds_read_b64_tr_b16 v[42:43], v18 offset:55808
    v_mfma_f32_32x32x16_bf16 v[112:127], v[48:51], a[44:47], v[112:127]
    ds_read_b128 a[60:63], v17 offset:32768
    ds_read_b64_tr_b16 v[44:45], v18 offset:63488
    ds_read_b64_tr_b16 v[46:47], v18 offset:64000
    v_mfma_f32_32x32x16_bf16 v[128:143], a[40:43], v[52:55], v[128:143]
    buffer_load_dwordx4 v4, s[24:27], s72 offen offset:2048 lds
    v_mfma_f32_32x32x16_bf16 v[144:159], a[44:47], v[52:55], v[144:159]
    buffer_load_dwordx4 v5, s[24:27], s72 offen offset:3072 lds
    s_add_u32 m0, s71, 0x24000
    s_add_u32 s99, s99, 1
    s_and_b32 s99, s99, 7
    s_lshl_b32 s72, s99, 7
    s_waitcnt lgkmcnt(6)
    v_add_u32 v10, 0x10000, v10
    v_add_u32 v11, 0x10000, v11
    v_add_u32 v12, 0x10000, v12
    v_add_u32 v13, 0x10000, v13
    v_add_u32 v14, 0x10000, v14
    v_add_u32 v15, 0x10000, v15
    v_add_u32 v16, 0x10000, v16
    v_add_u32 v17, 0x10000, v17
    v_add_u32 v18, 0x10000, v18
    s_waitcnt vmcnt(12)
    s_barrier
    v_mfma_f32_32x32x16_bf16 v[96:111], v[32:35], a[48:51], v[96:111]
    ds_read_b128 a[64:67], v10 offset:0
    ds_read_b64_tr_b16 v[48:49], v18 offset:16384
    ds_read_b64_tr_b16 v[50:51], v18 offset:16896
    v_mfma_f32_32x32x16_bf16 v[112:127], v[32:35], a[52:55], v[112:127]
    ds_read_b128 a[68:71], v14 offset:0
    ds_read_b64_tr_b16 v[52:53], v18 offset:24576
    ds_read_b64_tr_b16 v[54:55], v18 offset:25088
    v_mfma_f32_32x32x16_bf16 v[128:143], a[48:51], v[36:39], v[128:143]
    buffer_load_dwordx4 v6, s[28:31], s73 offen offset:0 lds
    v_mfma_f32_32x32x16_bf16 v[144:159], a[52:55], v[36:39], v[144:159]
    buffer_load_dwordx4 v7, s[28:31], s73 offen offset:1024 lds
    s_waitcnt lgkmcnt(6)
    v_mfma_f32_32x32x16_bf16 v[96:111], v[40:43], a[56:59], v[96:111]
    ds_read_b128 a[72:75], v11 offset:0
    ds_read_b64_tr_b16 v[32:33], v18 offset:18432
    ds_read_b64_tr_b16 v[34:35], v18 offset:18944
    v_mfma_f32_32x32x16_bf16 v[112:127], v[40:43], a[60:63], v[112:127]
    ds_read_b128 a[76:79], v15 offset:0
    ds_read_b64_tr_b16 v[36:37], v18 offset:26624
    ds_read_b64_tr_b16 v[38:39], v18 offset:27136
    v_mfma_f32_32x32x16_bf16 v[128:143], a[56:59], v[44:47], v[128:143]
    buffer_load_dwordx4 v8, s[28:31], s73 offen offset:2048 lds
    v_mfma_f32_32x32x16_bf16 v[144:159], a[60:63], v[44:47], v[144:159]
    buffer_load_dwordx4 v9, s[28:31], s73 offen offset:3072 lds
    s_waitcnt lgkmcnt(6)
    v_mfma_f32_32x32x16_bf16 v[96:111], v[48:51], a[64:67], v[96:111]
    ds_read_b128 a[80:83], v12 offset:0
    ds_read_b64_tr_b16 v[40:41], v18 offset:20480
    ds_read_b64_tr_b16 v[42:43], v18 offset:20992
    v_mfma_f32_32x32x16_bf16 v[112:127], v[48:51], a[68:71], v[112:127]
    ds_read_b128 a[84:87], v16 offset:0
    ds_read_b64_tr_b16 v[44:45], v18 offset:28672
    ds_read_b64_tr_b16 v[46:47], v18 offset:29184
    v_mfma_f32_32x32x16_bf16 v[128:143], a[64:67], v[52:55], v[128:143]
    s_add_u32 m0, s71, 0x0
    s_mul_i32 s73, s99, 196608
    s_add_u32 s73, s73, s101
    buffer_load_dwordx4 v2, s[24:27], s72 offen offset:0 lds
    v_mfma_f32_32x32x16_bf16 v[144:159], a[68:71], v[52:55], v[144:159]
    buffer_load_dwordx4 v3, s[24:27], s72 offen offset:1024 lds
    s_waitcnt lgkmcnt(6)
    v_mfma_f32_32x32x16_bf16 v[96:111], v[32:35], a[72:75], v[96:111]
    ds_read_b128 a[88:91], v13 offset:0
    ds_read_b64_tr_b16 v[48:49], v18 offset:22528
    ds_read_b64_tr_b16 v[50:51], v18 offset:23040
    v_mfma_f32_32x32x16_bf16 v[112:127], v[32:35], a[76:79], v[112:127]
    ds_read_b128 a[92:95], v17 offset:0
    ds_read_b64_tr_b16 v[52:53], v18 offset:30720
    ds_read_b64_tr_b16 v[54:55], v18 offset:31232
    v_mfma_f32_32x32x16_bf16 v[128:143], a[72:75], v[36:39], v[128:143]
    buffer_load_dwordx4 v4, s[24:27], s72 offen offset:2048 lds
    v_mfma_f32_32x32x16_bf16 v[144:159], a[76:79], v[36:39], v[144:159]
    buffer_load_dwordx4 v5, s[24:27], s72 offen offset:3072 lds
    s_add_u32 m0, s71, 0x4000
    s_add_u32 s99, s99, 1
    s_and_b32 s99, s99, 7
    s_lshl_b32 s72, s99, 7
    s_waitcnt lgkmcnt(6)
    s_waitcnt vmcnt(12)
    s_barrier
    v_mfma_f32_32x32x16_bf16 v[96:111], v[40:43], a[80:83], v[96:111]
    ds_read_b128 a[96:99], v10 offset:32768
    ds_read_b64_tr_b16 v[32:33], v18 offset:49152
    ds_read_b64_tr_b16 v[34:35], v18 offset:49664
    v_mfma_f32_32x32x16_bf16 v[112:127], v[40:43], a[84:87], v[112:127]
    ds_read_b128 a[100:103], v14 offset:32768
    ds_read_b64_tr_b16 v[36:37], v18 offset:57344
    ds_read_b64_tr_b16 v[38:39], v18 offset:57856
    v_mfma_f32_32x32x16_bf16 v[128:143], a[80:83], v[44:47], v[128:143]
    buffer_load_dwordx4 v6, s[28:31], s73 offen offset:0 lds
    v_mfma_f32_32x32x16_bf16 v[144:159], a[84:87], v[44:47], v[144:159]
    buffer_load_dwordx4 v7, s[28:31], s73 offen offset:1024 lds
    s_waitcnt lgkmcnt(6)
    v_mfma_f32_32x32x16_bf16 v[96:111], v[48:51], a[88:91], v[96:111]
    ds_read_b128 a[104:107], v11 offset:32768
    ds_read_b64_tr_b16 v[40:41], v18 offset:51200
    ds_read_b64_tr_b16 v[42:43], v18 offset:51712
    v_mfma_f32_32x32x16_bf16 v[112:127], v[48:51], a[92:95], v[112:127]
    ds_read_b128 a[108:111], v15 offset:32768
    ds_read_b64_tr_b16 v[44:45], v18 offset:59392
    ds_read_b64_tr_b16 v[46:47], v18 offset:59904
    v_mfma_f32_32x32x16_bf16 v[128:143], a[88:91], v[52:55], v[128:143]
    buffer_load_dwordx4 v8, s[28:31], s73 offen offset:2048 lds
    v_mfma_f32_32x32x16_bf16 v[144:159], a[92:95], v[52:55], v[144:159]
    buffer_load_dwordx4 v9, s[28:31], s73 offen offset:3072 lds
    s_waitcnt lgkmcnt(6)
    v_mfma_f32_32x32x16_bf16 v[96:111], v[32:35], a[96:99], v[96:111]
    ds_read_b128 a[112:115], v12 offset:32768
    ds_read_b64_tr_b16 v[48:49], v18 offset:53248
    ds_read_b64_tr_b16 v[50:51], v18 offset:53760
    v_mfma_f32_32x32x16_bf16 v[112:127], v[32:35], a[100:103], v[112:127]
    ds_read_b128 a[116:119], v16 offset:32768
    ds_read_b64_tr_b16 v[52:53], v18 offset:61440
    ds_read_b64_tr_b16 v[54:55], v18 offset:61952
    v_mfma_f32_32x32x16_bf16 v[128:143], a[96:99], v[36:39], v[128:143]
    s_add_u32 m0, s71, 0x8000
    s_mul_i32 s73, s99, 196608
    s_add_u32 s73, s73, s101
    buffer_load_dwordx4 v2, s[24:27], s72 offen offset:0 lds
    v_mfma_f32_32x32x16_bf16 v[144:159], a[100:103], v[36:39], v[144:159]
    buffer_load_dwordx4 v3, s[24:27], s72 offen offset:1024 lds
    s_waitcnt lgkmcnt(6)
    v_mfma_f32_32x32x16_bf16 v[96:111], v[40:43], a[104:107], v[96:111]
    ds_read_b128 a[120:123], v13 offset:32768
    ds_read_b64_tr_b16 v[32:33], v18 offset:55296
    ds_read_b64_tr_b16 v[34:35], v18 offset:55808
    v_mfma_f32_32x32x16_bf16 v[112:127], v[40:43], a[108:111], v[112:127]
    ds_read_b128 a[124:127], v17 offset:32768
    ds_read_b64_tr_b16 v[36:37], v18 offset:63488
    ds_read_b64_tr_b16 v[38:39], v18 offset:64000
    v_mfma_f32_32x32x16_bf16 v[128:143], a[104:107], v[44:47], v[128:143]
    buffer_load_dwordx4 v4, s[24:27], s72 offen offset:2048 lds
    v_mfma_f32_32x32x16_bf16 v[144:159], a[108:111], v[44:47], v[144:159]
    buffer_load_dwordx4 v5, s[24:27], s72 offen offset:3072 lds
    s_add_u32 m0, s71, 0xc000
    s_add_u32 s99, s99, 1
    s_and_b32 s99, s99, 7
    s_lshl_b32 s72, s99, 7
    s_waitcnt lgkmcnt(6)
    v_add_u32 v10, 0x10000, v10
    v_add_u32 v11, 0x10000, v11
    v_add_u32 v12, 0x10000, v12
    v_add_u32 v13, 0x10000, v13
    v_add_u32 v14, 0x10000, v14
    v_add_u32 v15, 0x10000, v15
    v_add_u32 v16, 0x10000, v16
    v_add_u32 v17, 0x10000, v17
    v_add_u32 v18, 0x10000, v18
    s_waitcnt vmcnt(12)
    s_barrier
    v_mfma_f32_32x32x16_bf16 v[96:111], v[48:51], a[112:115], v[96:111]
    ds_read_b128 a[128:131], v10 offset:0
    ds_read_b64_tr_b16 v[40:41], v18 offset:16384
    ds_read_b64_tr_b16 v[42:43], v18 offset:16896
    v_mfma_f32_32x32x16_bf16 v[112:127], v[48:51], a[116:119], v[112:127]
    ds_read_b128 a[132:135], v14 offset:0
    ds_read_b64_tr_b16 v[44:45], v18 offset:24576
    ds_read_b64_tr_b16 v[46:47], v18 offset:25088
    v_mfma_f32_32x32x16_bf16 v[128:143], a[112:115], v[52:55], v[128:143]
    buffer_load_dwordx4 v6, s[28:31], s73 offen offset:0 lds
    v_mfma_f32_32x32x16_bf16 v[144:159], a[116:119], v[52:55], v[144:159]
    buffer_load_dwordx4 v7, s[28:31], s73 offen offset:1024 lds
    s_waitcnt lgkmcnt(6)
    v_mfma_f32_32x32x16_bf16 v[96:111], v[32:35], a[120:123], v[96:111]
    ds_read_b128 a[136:139], v11 offset:0
    ds_read_b64_tr_b16 v[48:49], v18 offset:18432
    ds_read_b64_tr_b16 v[50:51], v18 offset:18944
    v_mfma_f32_32x32x16_bf16 v[112:127], v[32:35], a[124:127], v[112:127]
    ds_read_b128 a[140:143], v15 offset:0
    ds_read_b64_tr_b16 v[52:53], v18 offset:26624
    ds_read_b64_tr_b16 v[54:55], v18 offset:27136
    v_mfma_f32_32x32x16_bf16 v[128:143], a[120:123], v[36:39], v[128:143]
    buffer_load_dwordx4 v8, s[28:31], s73 offen offset:2048 lds
    v_mfma_f32_32x32x16_bf16 v[144:159], a[124:127], v[36:39], v[144:159]
    buffer_load_dwordx4 v9, s[28:31], s73 offen offset:3072 lds
    s_waitcnt lgkmcnt(6)
    v_mfma_f32_32x32x16_bf16 v[96:111], v[40:43], a[128:131], v[96:111]
    ds_read_b128 a[144:147], v12 offset:0
    ds_read_b64_tr_b16 v[32:33], v18 offset:20480
    ds_read_b64_tr_b16 v[34:35], v18 offset:20992
    v_mfma_f32_32x32x16_bf16 v[112:127], v[40:43], a[132:135], v[112:127]
    ds_read_b128 a[148:151], v16 offset:0
    ds_read_b64_tr_b16 v[36:37], v18 offset:28672
    ds_read_b64_tr_b16 v[38:39], v18 offset:29184
    v_mfma_f32_32x32x16_bf16 v[128:143], a[128:131], v[44:47], v[128:143]
    s_add_u32 m0, s71, 0x10000
    s_mul_i32 s73, s99, 196608
    s_add_u32 s73, s73, s101
    buffer_load_dwordx4 v2, s[24:27], s72 offen offset:0 lds
    v_mfma_f32_32x32x16_bf16 v[144:159], a[132:135], v[44:47], v[144:159]
    buffer_load_dwordx4 v3, s[24:27], s72 offen offset:1024 lds
    s_waitcnt lgkmcnt(6)
    v_mfma_f32_32x32x16_bf16 v[96:111], v[48:51], a[136:139], v[96:111]
    ds_read_b128 a[152:155], v13 offset:0
    ds_read_b64_tr_b16 v[40:41], v18 offset:22528
    ds_read_b64_tr_b16 v[42:43], v18 offset:23040
    v_mfma_f32_32x32x16_bf16 v[112:127], v[48:51], a[140:143], v[112:127]
    ds_read_b128 a[156:159], v17 offset:0
    ds_read_b64_tr_b16 v[44:45], v18 offset:30720
    ds_read_b64_tr_b16 v[46:47], v18 offset:31232
    v_mfma_f32_32x32x16_bf16 v[128:143], a[136:139], v[52:55], v[128:143]
    buffer_load_dwordx4 v4, s[24:27], s72 offen offset:2048 lds
    v_mfma_f32_32x32x16_bf16 v[144:159], a[140:143], v[52:55], v[144:159]
    buffer_load_dwordx4 v5, s[24:27], s72 offen offset:3072 lds
    s_add_u32 m0, s71, 0x14000
    s_add_u32 s99, s99, 1
    s_and_b32 s99, s99, 7
    s_lshl_b32 s72, s99, 7
    s_waitcnt lgkmcnt(6)
    v_add_u32 v10, 0xfffe0000, v10
    v_add_u32 v11, 0xfffe0000, v11
    v_add_u32 v12, 0xfffe0000, v12
    v_add_u32 v13, 0xfffe0000, v13
    v_add_u32 v14, 0xfffe0000, v14
    v_add_u32 v15, 0xfffe0000, v15
    v_add_u32 v16, 0xfffe0000, v16
    v_add_u32 v17, 0xfffe0000, v17
    v_add_u32 v18, 0xfffe0000, v18
    s_waitcnt vmcnt(12)
    s_barrier
    v_mfma_f32_32x32x16_bf16 v[96:111], v[32:35], a[144:147], v[96:111]
    ds_read_b128 a[160:163], v10 offset:0
    ds_read_b64_tr_b16 v[48:49], v18 offset:16384
    ds_read_b64_tr_b16 v[50:51], v18 offset:16896
    v_mfma_f32_32x32x16_bf16 v[112:127], v[32:35], a[148:151], v[112:127]
    ds_read_b128 a[164:167], v14 offset:0
    ds_read_b64_tr_b16 v[52:53], v18 offset:24576
    ds_read_b64_tr_b16 v[54:55], v18 offset:25088
    v_mfma_f32_32x32x16_bf16 v[128:143], a[144:147], v[36:39], v[128:143]
    buffer_load_dwordx4 v6, s[28:31], s73 offen offset:0 lds
    v_mfma_f32_32x32x16_bf16 v[144:159], a[148:151], v[36:39], v[144:159]
    buffer_load_dwordx4 v7, s[28:31], s73 offen offset:1024 lds
    s_waitcnt lgkmcnt(6)
    v_mfma_f32_32x32x16_bf16 v[96:111], v[40:43], a[152:155], v[96:111]
    ds_read_b128 a[168:171], v11 offset:0
    ds_read_b64_tr_b16 v[32:33], v18 offset:18432
    ds_read_b64_tr_b16 v[34:35], v18 offset:18944
    v_mfma_f32_32x32x16_bf16 v[112:127], v[40:43], a[156:159], v[112:127]
    ds_read_b128 a[172:175], v15 offset:0
    ds_read_b64_tr_b16 v[36:37], v18 offset:26624
    ds_read_b64_tr_b16 v[38:39], v18 offset:27136
    v_mfma_f32_32x32x16_bf16 v[128:143], a[152:155], v[44:47], v[128:143]
    buffer_load_dwordx4 v8, s[28:31], s73 offen offset:2048 lds
    v_mfma_f32_32x32x16_bf16 v[144:159], a[156:159], v[44:47], v[144:159]
    buffer_load_dwordx4 v9, s[28:31], s73 offen offset:3072 lds
    s_waitcnt lgkmcnt(6)
    v_mfma_f32_32x32x16_bf16 v[96:111], v[48:51], a[160:163], v[96:111]
    ds_read_b128 a[176:179], v12 offset:0
    ds_read_b64_tr_b16 v[40:41], v18 offset:20480
    ds_read_b64_tr_b16 v[42:43], v18 offset:20992
    v_mfma_f32_32x32x16_bf16 v[112:127], v[48:51], a[164:167], v[112:127]
    ds_read_b128 a[180:183], v16 offset:0
    ds_read_b64_tr_b16 v[44:45], v18 offset:28672
    ds_read_b64_tr_b16 v[46:47], v18 offset:29184
    v_mfma_f32_32x32x16_bf16 v[128:143], a[160:163], v[52:55], v[128:143]
    s_add_u32 m0, s71, 0x18000
    s_and_b32 s100, s100, 7
    s_mul_i32 s74, s100, 196608
    buffer_load_dwordx4 v6, s[28:31], s74 offen offset:0 lds
    v_mfma_f32_32x32x16_bf16 v[144:159], a[164:167], v[52:55], v[144:159]
    buffer_load_dwordx4 v7, s[28:31], s74 offen offset:1024 lds
    s_waitcnt lgkmcnt(6)
    v_mfma_f32_32x32x16_bf16 v[96:111], v[32:35], a[168:171], v[96:111]
    ds_read_b128 a[184:187], v13 offset:0
    ds_read_b64_tr_b16 v[48:49], v18 offset:22528
    ds_read_b64_tr_b16 v[50:51], v18 offset:23040
    v_mfma_f32_32x32x16_bf16 v[112:127], v[32:35], a[172:175], v[112:127]
    ds_read_b128 a[188:191], v17 offset:0
    ds_read_b64_tr_b16 v[52:53], v18 offset:30720
    ds_read_b64_tr_b16 v[54:55], v18 offset:31232
    v_mfma_f32_32x32x16_bf16 v[128:143], a[168:171], v[36:39], v[128:143]
    buffer_load_dwordx4 v8, s[28:31], s74 offen offset:2048 lds
    v_mfma_f32_32x32x16_bf16 v[144:159], a[172:175], v[36:39], v[144:159]
    buffer_load_dwordx4 v9, s[28:31], s74 offen offset:3072 lds
    s_add_u32 s100, s100, 2
    s_add_u32 m0, s71, 0x1c000
    s_and_b32 s100, s100, 7
    s_mul_i32 s74, s100, 196608
    s_waitcnt lgkmcnt(6)
    s_waitcnt vmcnt(12)
    s_barrier
    v_mfma_f32_32x32x16_bf16 v[96:111], v[40:43], a[176:179], v[96:111]
    ds_read_b128 a[192:195], v10 offset:32768
    ds_read_b64_tr_b16 v[32:33], v18 offset:49152
    ds_read_b64_tr_b16 v[34:35], v18 offset:49664
    v_mfma_f32_32x32x16_bf16 v[112:127], v[40:43], a[180:183], v[112:127]
    ds_read_b128 a[196:199], v14 offset:32768
    ds_read_b64_tr_b16 v[36:37], v18 offset:57344
    ds_read_b64_tr_b16 v[38:39], v18 offset:57856
    v_mfma_f32_32x32x16_bf16 v[128:143], a[176:179], v[44:47], v[128:143]
    buffer_load_dwordx4 v6, s[28:31], s74 offen offset:0 lds
    v_mfma_f32_32x32x16_bf16 v[144:159], a[180:183], v[44:47], v[144:159]
    buffer_load_dwordx4 v7, s[28:31], s74 offen offset:1024 lds
    s_waitcnt lgkmcnt(6)
    v_mfma_f32_32x32x16_bf16 v[96:111], v[48:51], a[184:187], v[96:111]
    ds_read_b128 a[200:203], v11 offset:32768
    ds_read_b64_tr_b16 v[40:41], v18 offset:51200
    ds_read_b64_tr_b16 v[42:43], v18 offset:51712
    v_mfma_f32_32x32x16_bf16 v[112:127], v[48:51], a[188:191], v[112:127]
    ds_read_b128 a[204:207], v15 offset:32768
    ds_read_b64_tr_b16 v[44:45], v18 offset:59392
    ds_read_b64_tr_b16 v[46:47], v18 offset:59904
    v_mfma_f32_32x32x16_bf16 v[128:143], a[184:187], v[52:55], v[128:143]
    buffer_load_dwordx4 v8, s[28:31], s74 offen offset:2048 lds
    v_mfma_f32_32x32x16_bf16 v[144:159], a[188:191], v[52:55], v[144:159]
    buffer_load_dwordx4 v9, s[28:31], s74 offen offset:3072 lds
    s_add_u32 s100, s100, 2
    s_waitcnt lgkmcnt(6)
    v_mfma_f32_32x32x16_bf16 v[96:111], v[32:35], a[192:195], v[96:111]
    ds_read_b128 a[208:211], v12 offset:32768
    ds_read_b64_tr_b16 v[48:49], v18 offset:53248
    ds_read_b64_tr_b16 v[50:51], v18 offset:53760
    v_mfma_f32_32x32x16_bf16 v[112:127], v[32:35], a[196:199], v[112:127]
    ds_read_b128 a[212:215], v16 offset:32768
    ds_read_b64_tr_b16 v[52:53], v18 offset:61440
    ds_read_b64_tr_b16 v[54:55], v18 offset:61952
    v_mfma_f32_32x32x16_bf16 v[128:143], a[192:195], v[36:39], v[128:143]
    s_add_u32 m0, s71, 0x20000
    s_and_b32 s100, s100, 7
    s_mul_i32 s74, s100, 196608
    buffer_load_dwordx4 v6, s[28:31], s74 offen offset:0 lds
    v_mfma_f32_32x32x16_bf16 v[144:159], a[196:199], v[36:39], v[144:159]
    buffer_load_dwordx4 v7, s[28:31], s74 offen offset:1024 lds
    s_waitcnt lgkmcnt(6)
    v_mfma_f32_32x32x16_bf16 v[96:111], v[40:43], a[200:203], v[96:111]
    ds_read_b128 a[216:219], v13 offset:32768
    ds_read_b64_tr_b16 v[32:33], v18 offset:55296
    ds_read_b64_tr_b16 v[34:35], v18 offset:55808
    v_mfma_f32_32x32x16_bf16 v[112:127], v[40:43], a[204:207], v[112:127]
    ds_read_b128 a[220:223], v17 offset:32768
    ds_read_b64_tr_b16 v[36:37], v18 offset:63488
    ds_read_b64_tr_b16 v[38:39], v18 offset:64000
    v_mfma_f32_32x32x16_bf16 v[128:143], a[200:203], v[44:47], v[128:143]
    buffer_load_dwordx4 v8, s[28:31], s74 offen offset:2048 lds
    v_mfma_f32_32x32x16_bf16 v[144:159], a[204:207], v[44:47], v[144:159]
    buffer_load_dwordx4 v9, s[28:31], s74 offen offset:3072 lds
    s_add_u32 s100, s100, 2
    s_add_u32 m0, s71, 0x24000
    s_and_b32 s100, s100, 7
    s_mul_i32 s74, s100, 196608
    s_waitcnt lgkmcnt(6)
    v_add_u32 v10, 0x10000, v10
    v_add_u32 v11, 0x10000, v11
    v_add_u32 v12, 0x10000, v12
    v_add_u32 v13, 0x10000, v13
    v_add_u32 v14, 0x10000, v14
    v_add_u32 v15, 0x10000, v15
    v_add_u32 v16, 0x10000, v16
    v_add_u32 v17, 0x10000, v17
    v_add_u32 v18, 0x10000, v18
    s_waitcnt vmcnt(12)
    s_barrier
    v_mfma_f32_32x32x16_bf16 v[96:111], v[48:51], a[208:211], v[96:111]
    ds_read_b128 a[224:227], v10 offset:0
    ds_read_b64_tr_b16 v[40:41], v18 offset:16384
    ds_read_b64_tr_b16 v[42:43], v18 offset:16896
    v_mfma_f32_32x32x16_bf16 v[112:127], v[48:51], a[212:215], v[112:127]
    ds_read_b128 a[228:231], v14 offset:0
    ds_read_b64_tr_b16 v[44:45], v18 offset:24576
    ds_read_b64_tr_b16 v[46:47], v18 offset:25088
    v_mfma_f32_32x32x16_bf16 v[128:143], a[208:211], v[52:55], v[128:143]
    buffer_load_dwordx4 v6, s[28:31], s74 offen offset:0 lds
    v_mfma_f32_32x32x16_bf16 v[144:159], a[212:215], v[52:55], v[144:159]
    buffer_load_dwordx4 v7, s[28:31], s74 offen offset:1024 lds
    s_waitcnt lgkmcnt(6)
    v_mfma_f32_32x32x16_bf16 v[96:111], v[32:35], a[216:219], v[96:111]
    ds_read_b128 a[232:235], v11 offset:0
    ds_read_b64_tr_b16 v[48:49], v18 offset:18432
    ds_read_b64_tr_b16 v[50:51], v18 offset:18944
    v_mfma_f32_32x32x16_bf16 v[112:127], v[32:35], a[220:223], v[112:127]
    ds_read_b128 a[236:239], v15 offset:0
    ds_read_b64_tr_b16 v[52:53], v18 offset:26624
    ds_read_b64_tr_b16 v[54:55], v18 offset:27136
    v_mfma_f32_32x32x16_bf16 v[128:143], a[216:219], v[36:39], v[128:143]
    buffer_load_dwordx4 v8, s[28:31], s74 offen offset:2048 lds
    v_mfma_f32_32x32x16_bf16 v[144:159], a[220:223], v[36:39], v[144:159]
    buffer_load_dwordx4 v9, s[28:31], s74 offen offset:3072 lds
    s_add_u32 s100, s100, 2
    s_waitcnt lgkmcnt(6)
    v_mfma_f32_32x32x16_bf16 v[96:111], v[40:43], a[224:227], v[96:111]
    ds_read_b128 a[240:243], v12 offset:0
    ds_read_b64_tr_b16 v[32:33], v18 offset:20480
    ds_read_b64_tr_b16 v[34:35], v18 offset:20992
    v_mfma_f32_32x32x16_bf16 v[112:127], v[40:43], a[228:231], v[112:127]
    ds_read_b128 a[244:247], v16 offset:0
    ds_read_b64_tr_b16 v[36:37], v18 offset:28672
    ds_read_b64_tr_b16 v[38:39], v18 offset:29184
    v_mfma_f32_32x32x16_bf16 v[128:143], a[224:227], v[44:47], v[128:143]
    s_lshl_b32 s92, s65, 2
    s_add_u32 s92, s92, s68
    s_lshl_b32 s92, s92, 1
    s_lshl_b32 s93, s64, 7
    s_add_u32 s92, s92, s93
    v_lshrrev_b32 v58, 5, v0
    v_mfma_f32_32x32x16_bf16 v[144:159], a[228:231], v[44:47], v[144:159]
    v_add_u32 v58, s92, v58
    v_and_b32 v56, 31, v0
    v_lshlrev_b32 v56, 4, v56
    v_lshl_add_u32 v57, v58, 10, v56
    s_waitcnt lgkmcnt(6)
    v_mfma_f32_32x32x16_bf16 v[96:111], v[48:51], a[232:235], v[96:111]
    ds_read_b128 a[248:251], v13 offset:0
    ds_read_b64_tr_b16 v[40:41], v18 offset:22528
    ds_read_b64_tr_b16 v[42:43], v18 offset:23040
    v_mfma_f32_32x32x16_bf16 v[112:127], v[48:51], a[236:239], v[112:127]
    ds_read_b128 a[252:255], v17 offset:0
    ds_read_b64_tr_b16 v[44:45], v18 offset:30720
    ds_read_b64_tr_b16 v[46:47], v18 offset:31232
    v_mfma_f32_32x32x16_bf16 v[128:143], a[232:235], v[52:55], v[128:143]
    v_mfma_f32_32x32x16_bf16 v[144:159], a[236:239], v[52:55], v[144:159]
    s_waitcnt lgkmcnt(6)
    s_waitcnt vmcnt(8)
    s_barrier
    v_mfma_f32_32x32x16_bf16 v[96:111], v[32:35], a[240:243], v[96:111]
    ds_read_b64_tr_b16 v[48:49], v18 offset:32768
    ds_read_b64_tr_b16 v[50:51], v18 offset:33280
    v_mfma_f32_32x32x16_bf16 v[112:127], v[32:35], a[244:247], v[112:127]
    v_mfma_f32_32x32x16_bf16 v[128:143], a[240:243], v[36:39], v[128:143]
    v_mfma_f32_32x32x16_bf16 v[144:159], a[244:247], v[36:39], v[144:159]
    s_waitcnt lgkmcnt(0)
    v_mfma_f32_32x32x16_bf16 v[96:111], v[40:43], a[248:251], v[96:111]
    ds_read_b64_tr_b16 v[52:53], v18 offset:34816
    ds_read_b64_tr_b16 v[54:55], v18 offset:35328
    v_mfma_f32_32x32x16_bf16 v[112:127], v[40:43], a[252:255], v[112:127]
    v_mfma_f32_32x32x16_bf16 v[128:143], a[248:251], v[44:47], v[128:143]
    v_mfma_f32_32x32x16_bf16 v[144:159], a[252:255], v[44:47], v[144:159]
    buffer_load_dwordx4 v[2:5], v57, s[24:27], 0 offen offset:0
    buffer_load_dwordx4 v[6:9], v57, s[24:27], 0 offen offset:512
    buffer_load_dwordx4 v[10:13], v56, s[56:59], 0 offen offset:0
    buffer_load_dwordx4 v[14:17], v56, s[56:59], 0 offen offset:512
    v_mfma_f32_32x32x16_bf16 v[224:239], v[48:51], a[0:3], 0
    ds_read_b64_tr_b16 v[40:41], v18 offset:36864
    ds_read_b64_tr_b16 v[42:43], v18 offset:37376
    v_cvt_pk_bf16_f32 v192, v96, v97
    v_cvt_pk_bf16_f32 v193, v98, v99
    v_cvt_pk_bf16_f32 v194, v100, v101
    v_cvt_pk_bf16_f32 v195, v102, v103
    v_mfma_f32_32x32x16_bf16 v[240:255], v[48:51], a[4:7], 0
    v_cvt_pk_bf16_f32 v196, v104, v105
    v_cvt_pk_bf16_f32 v197, v106, v107
    v_cvt_pk_bf16_f32 v198, v108, v109
L_stubhead_1:
L_stub_1:
    s_cbranch_execz L_stub_5
    v_cvt_pk_bf16_f32 v199, v110, v111
    v_cvt_pk_bf16_f32 v200, v112, v113
    s_waitcnt lgkmcnt(2)
    v_mfma_f32_32x32x16_bf16 v[224:239], v[52:55], a[8:11], v[224:239]
    ds_read_b64_tr_b16 v[32:33], v18 offset:38912
    ds_read_b64_tr_b16 v[34:35], v18 offset:39424
    v_cvt_pk_bf16_f32 v201, v114, v115
    v_cvt_pk_bf16_f32 v202, v116, v117
    v_cvt_pk_bf16_f32 v203, v118, v119
    v_cvt_pk_bf16_f32 v204, v120, v121
    v_mfma_f32_32x32x16_bf16 v[240:255], v[52:55], a[12:15], v[240:255]
    v_cvt_pk_bf16_f32 v205, v122, v123
    v_cvt_pk_bf16_f32 v206, v124, v125
    v_cvt_pk_bf16_f32 v207, v126, v127
    v_mov_b32 v60, 0x3f803f80
    v_mov_b32 v61, 0x3f803f80
    s_waitcnt lgkmcnt(2)
    v_mfma_f32_32x32x16_bf16 v[224:239], v[40:43], a[16:19], v[224:239]
    ds_read_b64_tr_b16 v[36:37], v18 offset:40960
    ds_read_b64_tr_b16 v[38:39], v18 offset:41472
    v_mov_b32 v62, 0x3f803f80
    v_mov_b32 v63, 0x3f803f80
    v_mfma_f32_32x32x16_bf16 v[240:255], v[40:43], a[20:23], v[240:255]
    buffer_store_dwordx4 v[60:63], v29, s[32:35], s3 offen sc1
    s_waitcnt lgkmcnt(2)
    v_mfma_f32_32x32x16_bf16 v[224:239], v[32:35], a[24:27], v[224:239]
    ds_read_b64_tr_b16 v[40:41], v18 offset:43008
    ds_read_b64_tr_b16 v[42:43], v18 offset:43520
    v_mfma_f32_32x32x16_bf16 v[240:255], v[32:35], a[28:31], v[240:255]
    buffer_store_dwordx4 v[192:195], v1, s[32:35], s80 offen sc1
    v_cvt_pk_bf16_f32 v208, v128, v129
    v_cvt_pk_bf16_f32 v209, v130, v131
    s_waitcnt lgkmcnt(2)
    v_mfma_f32_32x32x16_bf16 v[224:239], v[36:39], a[32:35], v[224:239]
    ds_read_b64_tr_b16 v[32:33], v18 offset:45056
    ds_read_b64_tr_b16 v[34:35], v18 offset:45568
    v_cvt_pk_bf16_f32 v210, v132, v133
    v_cvt_pk_bf16_f32 v211, v134, v135
    v_mfma_f32_32x32x16_bf16 v[240:255], v[36:39], a[36:39], v[240:255]
    buffer_store_dwordx4 v[196:199], v1, s[32:35], s81 offen sc1
    v_cvt_pk_bf16_f32 v212, v136, v137
    v_cvt_pk_bf16_f32 v213, v138, v139
    s_waitcnt lgkmcnt(2)
    v_mfma_f32_32x32x16_bf16 v[224:239], v[40:43], a[40:43], v[224:239]
    ds_read_b64_tr_b16 v[36:37], v18 offset:47104
    ds_read_b64_tr_b16 v[38:39], v18 offset:47616
    v_cvt_pk_bf16_f32 v214, v140, v141
    v_cvt_pk_bf16_f32 v215, v142, v143
    v_mfma_f32_32x32x16_bf16 v[240:255], v[40:43], a[44:47], v[240:255]
    buffer_store_dwordx4 v[200:203], v1, s[32:35], s82 offen sc1
    v_cvt_pk_bf16_f32 v216, v144, v145
    v_cvt_pk_bf16_f32 v217, v146, v147
    v_mov_b32 v20, 0
    buffer_load_dword v30, v20, s[60:63], 0 offen sc1
    s_waitcnt lgkmcnt(2)
    v_mfma_f32_32x32x16_bf16 v[224:239], v[32:35], a[48:51], v[224:239]
    ds_read_b64_tr_b16 v[40:41], v18 offset:49152
    ds_read_b64_tr_b16 v[42:43], v18 offset:49664
    v_cvt_pk_bf16_f32 v218, v148, v149
    v_cvt_pk_bf16_f32 v219, v150, v151
    v_mfma_f32_32x32x16_bf16 v[240:255], v[32:35], a[52:55], v[240:255]
    buffer_store_dwordx4 v[204:207], v1, s[32:35], s83 offen sc1
    v_cvt_pk_bf16_f32 v220, v152, v153
    v_cvt_pk_bf16_f32 v221, v154, v155
    s_waitcnt lgkmcnt(2)
    v_mfma_f32_32x32x16_bf16 v[224:239], v[36:39], a[56:59], v[224:239]
    ds_read_b64_tr_b16 v[32:33], v18 offset:51200
    ds_read_b64_tr_b16 v[34:35], v18 offset:51712
    v_cvt_pk_bf16_f32 v222, v156, v157
    v_cvt_pk_bf16_f32 v223, v158, v159
    v_mfma_f32_32x32x16_bf16 v[240:255], v[36:39], a[60:63], v[240:255]
    buffer_store_dwordx4 v[208:211], v28, s[32:35], s84 offen offset:0 sc1
    s_waitcnt lgkmcnt(2)
    v_mfma_f32_32x32x16_bf16 v[224:239], v[40:43], a[64:67], v[224:239]
    ds_read_b64_tr_b16 v[36:37], v18 offset:53248
    ds_read_b64_tr_b16 v[38:39], v18 offset:53760
    v_mfma_f32_32x32x16_bf16 v[240:255], v[40:43], a[68:71], v[240:255]
    buffer_store_dwordx4 v[212:215], v28, s[32:35], s84 offen offset:512 sc1
    v_mov_b32 v56, 0
    v_mov_b32 v57, 0
    s_waitcnt lgkmcnt(2)
    v_mfma_f32_32x32x16_bf16 v[224:239], v[32:35], a[72:75], v[224:239]
    ds_read_b64_tr_b16 v[40:41], v18 offset:55296
    ds_read_b64_tr_b16 v[42:43], v18 offset:55808
    v_mfma_f32_32x32x16_bf16 v[240:255], v[32:35], a[76:79], v[240:255]
    buffer_store_dwordx4 v[216:219], v28, s[32:35], s85 offen offset:0 sc1
    s_waitcnt vmcnt(10)
    v_dot2_f32_bf16 v56, v2, v10, v56
    v_dot2_f32_bf16 v57, v3, v11, v57
    s_waitcnt lgkmcnt(2)
    v_mfma_f32_32x32x16_bf16 v[224:239], v[36:39], a[80:83], v[224:239]
    ds_read_b64_tr_b16 v[32:33], v18 offset:57344
    ds_read_b64_tr_b16 v[34:35], v18 offset:57856
    v_and_b32 v50, 31, v0
    v_lshrrev_b32 v49, 5, v0
    v_mfma_f32_32x32x16_bf16 v[240:255], v[36:39], a[84:87], v[240:255]
    buffer_store_dwordx4 v[220:223], v28, s[32:35], s85 offen offset:512 sc1
    v_dot2_f32_bf16 v56, v4, v12, v56
    v_dot2_f32_bf16 v57, v5, v13, v57
    s_waitcnt lgkmcnt(2)
    v_mfma_f32_32x32x16_bf16 v[224:239], v[40:43], a[88:91], v[224:239]
    ds_read_b64_tr_b16 v[36:37], v18 offset:59392
    ds_read_b64_tr_b16 v[38:39], v18 offset:59904
    v_lshlrev_b32 v49, 2, v49
    v_sub_u32 v50, v50, v49
    v_mfma_f32_32x32x16_bf16 v[240:255], v[40:43], a[92:95], v[240:255]
    ds_write_b128 v24, v[192:195] offset:0
    s_waitcnt vmcnt(10)
    v_dot2_f32_bf16 v56, v6, v14, v56
    v_dot2_f32_bf16 v57, v7, v15, v57
    s_waitcnt lgkmcnt(3)
    v_mfma_f32_32x32x16_bf16 v[224:239], v[32:35], a[96:99], v[224:239]
    ds_read_b64_tr_b16 v[40:41], v18 offset:61440
    ds_read_b64_tr_b16 v[42:43], v18 offset:61952
    v_mov_b32 v49, 0xff800000
    v_mov_b32 v48, 0
    v_mfma_f32_32x32x16_bf16 v[240:255], v[32:35], a[100:103], v[240:255]
    ds_write_b128 v24, v[196:199] offset:4096
    v_dot2_f32_bf16 v56, v8, v16, v56
    v_dot2_f32_bf16 v57, v9, v17, v57
    s_barrier
    s_waitcnt lgkmcnt(4)
    v_mfma_f32_32x32x16_bf16 v[224:239], v[36:39], a[104:107], v[224:239]
    ds_read_b64_tr_b16 v[32:33], v18 offset:63488
    ds_read_b64_tr_b16 v[34:35], v18 offset:64000
    v_cmp_le_i32 s[72:73], 0, v50
    v_cmp_le_i32 s[98:99], 1, v50
    v_mfma_f32_32x32x16_bf16 v[240:255], v[36:39], a[108:111], v[240:255]
    ds_write_b128 v25, v[200:203] offset:0
    s_mov_b32 s93, 0xd00000
    v_lshl_add_u32 v58, v58, 2, s93
    v_add_u32 v18, 0x10000, v18
    s_waitcnt lgkmcnt(4)
    v_mfma_f32_32x32x16_bf16 v[224:239], v[40:43], a[112:115], v[224:239]
    ds_read_b64_tr_b16 v[36:37], v18 offset:0
    ds_read_b64_tr_b16 v[38:39], v18 offset:512
    v_cmp_le_i32 vcc, 2, v50
    v_cndmask_b32 v64, v49, v48, s[72:73]
    v_mfma_f32_32x32x16_bf16 v[240:255], v[40:43], a[116:119], v[240:255]
    ds_write_b128 v25, v[204:207] offset:4096
    v_and_b32 v2, 31, v0
    v_add_f32 v56, v56, v57
    s_waitcnt lgkmcnt(4)
    v_mfma_f32_32x32x16_bf16 v[224:239], v[32:35], a[120:123], v[224:239]
    ds_read_b64_tr_b16 v[40:41], v18 offset:2048
    ds_read_b64_tr_b16 v[42:43], v18 offset:2560
    v_cndmask_b32 v80, v48, v49, s[72:73]
    v_cndmask_b32 v65, v49, v48, s[98:99]
    v_mfma_f32_32x32x16_bf16 v[240:255], v[32:35], a[124:127], v[240:255]
    ds_write_b128 v26, v[208:211] offset:0
    v_cmp_eq_u32 s[94:95], 0, v2
    v_mov_b32 v3, 0x7f000000
    s_waitcnt lgkmcnt(4)
    v_mfma_f32_32x32x16_bf16 v[224:239], v[36:39], a[128:131], v[224:239]
    ds_read_b64_tr_b16 v[32:33], v18 offset:4096
    ds_read_b64_tr_b16 v[34:35], v18 offset:4608
    v_cndmask_b32 v81, v48, v49, s[98:99]
    v_cndmask_b32 v66, v49, v48, vcc
    v_mfma_f32_32x32x16_bf16 v[240:255], v[36:39], a[132:135], v[240:255]
    ds_write_b128 v26, v[212:215] offset:512
    v_add_f32_dpp v56, v56, v56 row_ror:8 row_mask:0xf bank_mask:0xf
    v_cndmask_b32 v58, v3, v58, s[94:95]
    s_waitcnt lgkmcnt(4)
    v_mfma_f32_32x32x16_bf16 v[224:239], v[40:43], a[136:139], v[224:239]
    ds_read_b64_tr_b16 v[36:37], v18 offset:6144
    ds_read_b64_tr_b16 v[38:39], v18 offset:6656
    v_cndmask_b32 v82, v48, v49, vcc
    v_cmp_le_i32 s[72:73], 3, v50
    v_mfma_f32_32x32x16_bf16 v[240:255], v[40:43], a[140:143], v[240:255]
    ds_write_b128 v27, v[216:219] offset:0
    s_nop 0
    v_add_f32_dpp v56, v56, v56 row_ror:4 row_mask:0xf bank_mask:0xf
    s_waitcnt lgkmcnt(4)
    v_mfma_f32_32x32x16_bf16 v[224:239], v[32:35], a[144:147], v[224:239]
    ds_read_b64_tr_b16 v[40:41], v18 offset:8192
    ds_read_b64_tr_b16 v[42:43], v18 offset:8704
    v_cmp_le_i32 s[98:99], 8, v50
    v_cmp_le_i32 vcc, 9, v50
    v_mfma_f32_32x32x16_bf16 v[240:255], v[32:35], a[148:151], v[240:255]
    ds_write_b128 v27, v[220:223] offset:512
    v_and_b32 v19, 15, v0
    v_mul_u32_u24 v19, 1040, v19
    s_nop 1
    v_add_f32_dpp v56, v56, v56 row_ror:2 row_mask:0xf bank_mask:0xf
    s_waitcnt lgkmcnt(4)
    v_mfma_f32_32x32x16_bf16 v[224:239], v[36:39], a[152:155], v[224:239]
    ds_read_b64_tr_b16 v[32:33], v18 offset:10240
    ds_read_b64_tr_b16 v[34:35], v18 offset:10752
    v_add_u32 v19, 17408, v19
    v_cndmask_b32 v67, v49, v48, s[72:73]
    v_cndmask_b32 v83, v48, v49, s[72:73]
    v_mfma_f32_32x32x16_bf16 v[240:255], v[36:39], a[156:159], v[240:255]
    ds_write_b128 v19, v[60:63]
    s_nop 1
    v_add_f32_dpp v56, v56, v56 row_ror:1 row_mask:0xf bank_mask:0xf
    s_waitcnt lgkmcnt(4)
    v_mfma_f32_32x32x16_bf16 v[224:239], v[40:43], a[160:163], v[224:239]
    ds_read_b64_tr_b16 v[36:37], v18 offset:12288
    ds_read_b64_tr_b16 v[38:39], v18 offset:12800
    v_cndmask_b32 v68, v49, v48, s[98:99]
    v_cndmask_b32 v84, v48, v49, s[98:99]
    v_mfma_f32_32x32x16_bf16 v[240:255], v[40:43], a[164:167], v[240:255]
    v_bfe_u32 v20, v0, 2, 2
    v_lshrrev_b32 v21, 5, v0
    v_lshl_add_u32 v21, v21, 2, v20
    v_lshlrev_b32 v21, 7, v21
    v_and_b32 v22, 1, v0
    v_mov_b32 v57, v56
    s_nop 1
    v_permlane16_swap_b32 v57, v56
    s_waitcnt lgkmcnt(3)
    v_mfma_f32_32x32x16_bf16 v[224:239], v[32:35], a[168:171], v[224:239]
    ds_read_b64_tr_b16 v[40:41], v18 offset:14336
    ds_read_b64_tr_b16 v[42:43], v18 offset:14848
    v_cndmask_b32 v69, v49, v48, vcc
    v_cndmask_b32 v85, v48, v49, vcc
    v_mfma_f32_32x32x16_bf16 v[240:255], v[32:35], a[172:175], v[240:255]
    v_lshlrev_b32 v22, 1, v22
    v_bfe_u32 v23, v0, 4, 1
    v_add_u32 v22, v22, v23
    v_lshrrev_b32 v20, 1, v20
    v_lshlrev_b32 v20, 2, v20
    s_nop 1
    v_add_f32 v56, v56, v57
    v_mul_f32 v56, 0xbfb8aa3b, v56
    s_waitcnt lgkmcnt(2)
    v_mfma_f32_32x32x16_bf16 v[224:239], v[36:39], a[176:179], v[224:239]
    ds_read_b64_tr_b16 v[32:33], v18 offset:16384
    ds_read_b64_tr_b16 v[34:35], v18 offset:16896
    v_cmp_le_i32 s[72:73], 10, v50
    v_cmp_le_i32 s[98:99], 11, v50
    v_mfma_f32_32x32x16_bf16 v[240:255], v[36:39], a[180:183], v[240:255]
    v_bfe_u32 v23, v0, 1, 1
    v_lshl_add_u32 v21, v23, 3, v21
    s_lshl_b32 s76, s70, 16
    s_add_u32 s76, s76, 32768
    v_add_u32 v21, s76, v21
    v_exp_f32 v56, v56
    s_nop 0
    v_add_f32 v56, 1.0, v56
    s_waitcnt lgkmcnt(2)
    v_mfma_f32_32x32x16_bf16 v[224:239], v[40:43], a[184:187], v[224:239]
    ds_read_b64_tr_b16 v[36:37], v18 offset:18432
    ds_read_b64_tr_b16 v[38:39], v18 offset:18944
    v_cmp_le_i32 vcc, 16, v50
    v_cndmask_b32 v70, v49, v48, s[72:73]
    v_mfma_f32_32x32x16_bf16 v[240:255], v[40:43], a[188:191], v[240:255]
    s_lshl_b32 s77, s70, 2
    v_add_u32 v23, s77, v22
    v_xor_b32 v23, v23, v20
    v_lshl_add_u32 v177, v23, 4, v21
    v_xor_b32 v23, 4, v23
    v_rcp_f32 v56, v56
    s_nop 0
    buffer_store_dword v56, v58, s[32:35], 0 offen sc1
    s_waitcnt lgkmcnt(2)
    v_mfma_f32_32x32x16_bf16 v[224:239], v[32:35], a[192:195], v[224:239]
    ds_read_b64_tr_b16 v[40:41], v18 offset:20480
    ds_read_b64_tr_b16 v[42:43], v18 offset:20992
    v_cndmask_b32 v86, v48, v49, s[72:73]
    v_cndmask_b32 v71, v49, v48, s[98:99]
    v_mfma_f32_32x32x16_bf16 v[240:255], v[32:35], a[196:199], v[240:255]
    v_lshl_add_u32 v178, v23, 4, v21
    v_and_b32 v20, 31, v0
    s_lshl_b32 s76, s90, 5
    v_add_u32 v20, s76, v20
    s_mov_b32 s76, 0xd00000
    s_waitcnt lgkmcnt(2)
    v_mfma_f32_32x32x16_bf16 v[224:239], v[36:39], a[200:203], v[224:239]
    ds_read_b64_tr_b16 v[32:33], v18 offset:22528
    ds_read_b64_tr_b16 v[34:35], v18 offset:23040
    v_cndmask_b32 v87, v48, v49, s[98:99]
    v_cndmask_b32 v72, v49, v48, vcc
    v_mfma_f32_32x32x16_bf16 v[240:255], v[36:39], a[204:207], v[240:255]
    v_lshl_add_u32 v179, v20, 2, s76
    v_lshrrev_b32 v21, 5, v0
    v_lshlrev_b32 v21, 5, v21
    v_lshl_add_u32 v21, v20, 10, v21
    s_lshl_b32 s76, s91, 7
    s_waitcnt lgkmcnt(2)
    v_mfma_f32_32x32x16_bf16 v[224:239], v[40:43], a[208:211], v[224:239]
    ds_read_b64_tr_b16 v[36:37], v18 offset:24576
    ds_read_b64_tr_b16 v[38:39], v18 offset:25088
    v_cndmask_b32 v88, v48, v49, vcc
    v_cmp_le_i32 s[72:73], 17, v50
    v_mfma_f32_32x32x16_bf16 v[240:255], v[40:43], a[212:215], v[240:255]
    s_lshl_b32 s77, s70, 6
    s_add_u32 s76, s76, s77
    v_add_u32 v180, s76, v21
    s_lshl_b32 s76, s69, 13
    s_lshl_b32 s77, s70, 12
    s_waitcnt vmcnt(6)
    v_readfirstlane_b32 s75, v30
    s_nop 1
    s_cmp_lg_u32 s75, 0
    s_cbranch_scc1 L_nzd_3
    s_mov_b32 s74, 131072
    v_mov_b32 v143, 0
L_nz_2:
    buffer_load_dword v30, v143, s[60:63], 0 offen sc1
    s_waitcnt vmcnt(0)
    v_readfirstlane_b32 s75, v30
    s_nop 1
    s_cmp_lg_u32 s75, 0
    s_cbranch_scc1 L_nzd_3
    s_sub_u32 s74, s74, 1
    s_cmp_lg_u32 s74, 0
    s_cbranch_scc1 L_nz_2
L_nzd_3:
    s_waitcnt vmcnt(1)
    buffer_store_dword v30, v31, s[32:35], 0 offen offset:0 sc1
    s_waitcnt lgkmcnt(2)
    v_mfma_f32_32x32x16_bf16 v[224:239], v[32:35], a[216:219], v[224:239]
    ds_read_b64_tr_b16 v[40:41], v18 offset:26624
    ds_read_b64_tr_b16 v[42:43], v18 offset:27136
    v_cmp_le_i32 s[98:99], 18, v50
    v_cmp_le_i32 vcc, 19, v50
    v_mfma_f32_32x32x16_bf16 v[240:255], v[32:35], a[220:223], v[240:255]
    s_add_u32 s76, s76, s77
    v_add_u32 v181, s76, v1
    s_barrier
    s_waitcnt lgkmcnt(2)
    v_mfma_f32_32x32x16_bf16 v[224:239], v[36:39], a[224:227], v[224:239]
    ds_read_b64_tr_b16 v[32:33], v18 offset:28672
    ds_read_b64_tr_b16 v[34:35], v18 offset:29184
    v_cndmask_b32 v73, v49, v48, s[72:73]
    v_cndmask_b32 v89, v48, v49, s[72:73]
    v_mfma_f32_32x32x16_bf16 v[240:255], v[36:39], a[228:231], v[240:255]
    ds_read_b128 a[0:3], v162 offset:0
    ds_read_b128 a[32:35], v163 offset:0
    s_waitcnt lgkmcnt(4)
    v_mfma_f32_32x32x16_bf16 v[224:239], v[40:43], a[232:235], v[224:239]
    ds_read_b64_tr_b16 v[36:37], v18 offset:30720
    ds_read_b64_tr_b16 v[38:39], v18 offset:31232
    v_cndmask_b32 v74, v49, v48, s[98:99]
    v_cndmask_b32 v90, v48, v49, s[98:99]
    v_mfma_f32_32x32x16_bf16 v[240:255], v[40:43], a[236:239], v[240:255]
    ds_read_b128 a[36:39], v164 offset:0
    ds_read_b128 a[4:7], v162 offset:1024
    s_waitcnt lgkmcnt(6)
    v_mfma_f32_32x32x16_bf16 v[224:239], v[32:35], a[240:243], v[224:239]
    v_cndmask_b32 v75, v49, v48, vcc
    v_cndmask_b32 v91, v48, v49, vcc
    v_mfma_f32_32x32x16_bf16 v[240:255], v[32:35], a[244:247], v[240:255]
    ds_read_b128 a[40:43], v163 offset:1040
    ds_read_b128 a[44:47], v164 offset:1040
    s_waitcnt lgkmcnt(4)
    v_mfma_f32_32x32x16_bf16 v[224:239], v[36:39], a[248:251], v[224:239]
    v_cmp_le_i32 s[72:73], 24, v50
    v_cmp_le_i32 s[98:99], 25, v50
    v_mfma_f32_32x32x16_bf16 v[240:255], v[36:39], a[252:255], v[240:255]
    v_cmp_le_i32 vcc, 26, v50
    v_cndmask_b32 v76, v49, v48, s[72:73]
    v_cndmask_b32 v92, v48, v49, s[72:73]
    v_cndmask_b32 v77, v49, v48, s[98:99]
    v_cndmask_b32 v93, v48, v49, s[98:99]
    v_cndmask_b32 v78, v49, v48, vcc
    v_cndmask_b32 v94, v48, v49, vcc
    v_cmp_le_i32 s[72:73], 27, v50
    s_nop 1
    v_cndmask_b32 v79, v49, v48, s[72:73]
    v_cndmask_b32 v95, v48, v49, s[72:73]
    s_mov_b32 s92, 0x3eb8aa3b
    s_mov_b32 s93, 0x3eb8aa3b
    v_pk_mul_f32 v[224:225], v[224:225], s[92:93]
    v_pk_mul_f32 v[226:227], v[226:227], s[92:93]
    v_pk_mul_f32 v[228:229], v[228:229], s[92:93]
    v_pk_mul_f32 v[230:231], v[230:231], s[92:93]
    v_pk_mul_f32 v[232:233], v[232:233], s[92:93]
    v_pk_mul_f32 v[234:235], v[234:235], s[92:93]
    v_pk_mul_f32 v[236:237], v[236:237], s[92:93]
    v_pk_mul_f32 v[238:239], v[238:239], s[92:93]
    v_cvt_pk_bf16_f32 v48, v224, v225
    v_cvt_pk_bf16_f32 v49, v226, v227
    v_cvt_pk_bf16_f32 v50, v228, v229
    v_cvt_pk_bf16_f32 v51, v230, v231
    v_cvt_pk_bf16_f32 v56, v232, v233
    v_cvt_pk_bf16_f32 v57, v234, v235
    v_cvt_pk_bf16_f32 v58, v236, v237
    v_cvt_pk_bf16_f32 v59, v238, v239
    v_pk_mul_f32 v[240:241], v[240:241], s[92:93]
    v_pk_mul_f32 v[242:243], v[242:243], s[92:93]
    v_pk_mul_f32 v[244:245], v[244:245], s[92:93]
    v_pk_mul_f32 v[246:247], v[246:247], s[92:93]
    v_pk_mul_f32 v[248:249], v[248:249], s[92:93]
    v_pk_mul_f32 v[250:251], v[250:251], s[92:93]
    v_pk_mul_f32 v[252:253], v[252:253], s[92:93]
    v_pk_mul_f32 v[254:255], v[254:255], s[92:93]
    v_cvt_pk_bf16_f32 v52, v240, v241
    v_cvt_pk_bf16_f32 v53, v242, v243
    v_cvt_pk_bf16_f32 v54, v244, v245
    v_cvt_pk_bf16_f32 v55, v246, v247
    v_cvt_pk_bf16_f32 v60, v248, v249
    v_cvt_pk_bf16_f32 v61, v250, v251
    v_cvt_pk_bf16_f32 v62, v252, v253
    v_cvt_pk_bf16_f32 v63, v254, v255
    s_cmp_eq_u32 s69, 0
    s_cbranch_scc0 L_wr1
    v_mfma_f32_32x32x16_bf16 v[96:111], a[0:3], v[48:51], v[64:79]
    v_mfma_f32_32x32x16_bf16 v[112:127], a[0:3], v[52:55], 0
    s_nop 10
    v_exp_f32 v96, v96
    v_exp_f32 v97, v97
    v_exp_f32 v98, v98
    v_exp_f32 v99, v99
    v_cvt_pk_bf16_f32 v144, v96, v97
    v_exp_f32 v100, v100
    v_cvt_pk_bf16_f32 v145, v98, v99
    v_exp_f32 v101, v101
    v_exp_f32 v102, v102
    v_cvt_pk_bf16_f32 v146, v100, v101
    ds_read_b128 a[8:11], v162 offset:2048
    ds_read_b128 a[48:51], v163 offset:2080
    ds_read_b128 a[52:55], v164 offset:2080
    v_exp_f32 v103, v103
    v_exp_f32 v104, v104
    v_cvt_pk_bf16_f32 v147, v102, v103
    v_exp_f32 v105, v105
    v_exp_f32 v106, v106
    v_mfma_f32_32x32x16_bf16 v[192:207], a[32:35], v[144:147], 0
    v_exp_f32 v107, v107
    v_cvt_pk_bf16_f32 v148, v104, v105
    v_exp_f32 v108, v108
    v_exp_f32 v109, v109
    v_cvt_pk_bf16_f32 v149, v106, v107
    ds_read_b128 a[12:15], v162 offset:3072
    ds_read_b128 a[56:59], v163 offset:3120
    ds_read_b128 a[60:63], v164 offset:3120
    v_exp_f32 v110, v110
    v_exp_f32 v111, v111
    v_cvt_pk_bf16_f32 v150, v108, v109
    v_cvt_pk_bf16_f32 v151, v110, v111
    s_waitcnt lgkmcnt(8)
    v_mfma_f32_32x32x16_bf16 v[96:111], a[4:7], v[52:55], 0
    v_exp_f32 v112, v112
    v_exp_f32 v113, v113
    v_exp_f32 v114, v114
    v_mfma_f32_32x32x16_bf16 v[192:207], a[36:39], v[148:151], v[192:207]
    v_exp_f32 v115, v115
    v_cvt_pk_bf16_f32 v152, v112, v113
    v_exp_f32 v116, v116
    v_cvt_pk_bf16_f32 v153, v114, v115
    v_exp_f32 v117, v117
    v_exp_f32 v118, v118
    v_cvt_pk_bf16_f32 v154, v116, v117
    ds_read_b128 a[16:19], v162 offset:4096
    ds_read_b128 a[64:67], v163 offset:4160
    ds_read_b128 a[68:71], v164 offset:4160
    v_exp_f32 v119, v119
    v_exp_f32 v120, v120
    v_cvt_pk_bf16_f32 v155, v118, v119
    v_exp_f32 v121, v121
    v_exp_f32 v122, v122
    v_mfma_f32_32x32x16_bf16 v[208:223], a[32:35], v[152:155], 0
    v_exp_f32 v123, v123
    v_cvt_pk_bf16_f32 v156, v120, v121
    v_exp_f32 v124, v124
    v_exp_f32 v125, v125
    v_cvt_pk_bf16_f32 v157, v122, v123
    ds_read_b128 a[20:23], v162 offset:5120
    ds_read_b128 a[72:75], v163 offset:5200
    ds_read_b128 a[76:79], v164 offset:5200
    v_exp_f32 v126, v126
    v_exp_f32 v127, v127
    v_cvt_pk_bf16_f32 v158, v124, v125
    v_cvt_pk_bf16_f32 v159, v126, v127
    buffer_load_dword v140, v169, s[32:35], 0 offen sc1
    s_waitcnt lgkmcnt(11)
    v_mfma_f32_32x32x16_bf16 v[112:127], a[8:11], v[52:55], 0
    v_exp_f32 v96, v96
    v_exp_f32 v97, v97
    v_exp_f32 v98, v98
    v_mfma_f32_32x32x16_bf16 v[208:223], a[36:39], v[156:159], v[208:223]
    v_exp_f32 v99, v99
    v_cvt_pk_bf16_f32 v144, v96, v97
    v_exp_f32 v100, v100
    v_cvt_pk_bf16_f32 v145, v98, v99
    v_exp_f32 v101, v101
    v_exp_f32 v102, v102
    v_cvt_pk_bf16_f32 v146, v100, v101
    ds_read_b128 a[24:27], v162 offset:6144
    ds_read_b128 a[80:83], v163 offset:6240
    ds_read_b128 a[84:87], v164 offset:6240
    v_exp_f32 v103, v103
    v_exp_f32 v104, v104
    v_cvt_pk_bf16_f32 v147, v102, v103
    v_exp_f32 v105, v105
    v_exp_f32 v106, v106
    v_mfma_f32_32x32x16_bf16 v[208:223], a[40:43], v[144:147], v[208:223]
    v_exp_f32 v107, v107
    v_cvt_pk_bf16_f32 v148, v104, v105
    v_exp_f32 v108, v108
    v_exp_f32 v109, v109
    v_cvt_pk_bf16_f32 v149, v106, v107
    ds_read_b128 a[28:31], v162 offset:7168
    ds_read_b128 a[88:91], v163 offset:7280
    ds_read_b128 a[92:95], v164 offset:7280
    v_exp_f32 v110, v110
    v_exp_f32 v111, v111
    v_cvt_pk_bf16_f32 v150, v108, v109
    v_cvt_pk_bf16_f32 v151, v110, v111
    s_waitcnt lgkmcnt(14)
    v_mfma_f32_32x32x16_bf16 v[96:111], a[12:15], v[52:55], v[64:79]
    v_exp_f32 v112, v112
    v_exp_f32 v113, v113
    v_exp_f32 v114, v114
    v_mfma_f32_32x32x16_bf16 v[208:223], a[44:47], v[148:151], v[208:223]
    v_exp_f32 v115, v115
    v_cvt_pk_bf16_f32 v152, v112, v113
    v_exp_f32 v116, v116
    v_cvt_pk_bf16_f32 v153, v114, v115
    v_exp_f32 v117, v117
    v_exp_f32 v118, v118
    v_cvt_pk_bf16_f32 v154, v116, v117
    v_mov_b32 v24, -1
    v_mov_b32 v25, -1
    v_mov_b32 v26, -1
    v_exp_f32 v119, v119
    v_exp_f32 v120, v120
    v_cvt_pk_bf16_f32 v155, v118, v119
    v_exp_f32 v121, v121
    v_exp_f32 v122, v122
    v_mfma_f32_32x32x16_bf16 v[208:223], a[48:51], v[152:155], v[208:223]
    v_exp_f32 v123, v123
    v_cvt_pk_bf16_f32 v156, v120, v121
    v_exp_f32 v124, v124
    v_exp_f32 v125, v125
    v_cvt_pk_bf16_f32 v157, v122, v123
    v_mov_b32 v27, -1
    v_exp_f32 v126, v126
    v_exp_f32 v127, v127
    v_cvt_pk_bf16_f32 v158, v124, v125
    v_cvt_pk_bf16_f32 v159, v126, v127
    s_waitcnt lgkmcnt(0)
    s_barrier
    v_and_b32 v141, v170, v30
    s_waitcnt vmcnt(0)
    v_cmp_ne_u32 vcc, v140, v141
    s_nop 1
    s_cbranch_vccz L_polld_5
    s_mov_b32 s95, 131072
L_poll_4:
    buffer_load_dword v140, v169, s[32:35], 0 offen sc1
    s_waitcnt vmcnt(0)
    v_cmp_ne_u32 vcc, v140, v141
    s_nop 1
    s_cbranch_vccz L_polld_5
    s_sub_u32 s95, s95, 1
    s_cmp_lg_u32 s95, 0
    s_cbranch_scc1 L_poll_4
L_polld_5:
    v_mfma_f32_32x32x16_bf16 v[112:127], a[16:19], v[56:59], v[64:79]
    v_exp_f32 v96, v96
    v_exp_f32 v97, v97
    v_exp_f32 v98, v98
    v_mfma_f32_32x32x16_bf16 v[208:223], a[52:55], v[156:159], v[208:223]
    v_exp_f32 v99, v99
    v_cvt_pk_bf16_f32 v144, v96, v97
    v_exp_f32 v100, v100
    v_cvt_pk_bf16_f32 v145, v98, v99
    v_exp_f32 v101, v101
    v_exp_f32 v102, v102
    v_cvt_pk_bf16_f32 v146, v100, v101
    s_lshl_b32 s76, s2, 2
    s_add_u32 s76, s76, s68
    s_and_b32 s77, s76, 511
    buffer_load_dwordx4 a[96:99], v1, s[40:43], s12 offen offset:0 sc1
    buffer_load_dwordx4 a[128:131], v160, s[40:43], s14 offen offset:0 sc1
    v_exp_f32 v103, v103
    v_exp_f32 v104, v104
    v_cvt_pk_bf16_f32 v147, v102, v103
    v_exp_f32 v105, v105
    v_exp_f32 v106, v106
    v_mfma_f32_32x32x16_bf16 v[208:223], a[56:59], v[144:147], v[208:223]
    v_exp_f32 v107, v107
    v_cvt_pk_bf16_f32 v148, v104, v105
    v_exp_f32 v108, v108
    v_exp_f32 v109, v109
    v_cvt_pk_bf16_f32 v149, v106, v107
    s_lshl_b32 s77, s77, 10
    s_cmp_lt_u32 s76, 512
    s_cselect_b32 s92, s44, s48
    s_cselect_b32 s93, s45, s49
    s_add_u32 s92, s92, s77
    s_addc_u32 s93, s93, 0
    buffer_load_dwordx4 a[132:135], v161, s[40:43], s14 offen offset:0 sc1
    v_exp_f32 v110, v110
    v_exp_f32 v111, v111
    v_cvt_pk_bf16_f32 v150, v108, v109
    v_cvt_pk_bf16_f32 v151, v110, v111
    v_mfma_f32_32x32x16_bf16 v[96:111], a[16:19], v[60:63], 0
    v_exp_f32 v112, v112
    v_exp_f32 v113, v113
    v_exp_f32 v114, v114
    v_mfma_f32_32x32x16_bf16 v[208:223], a[60:63], v[148:151], v[208:223]
    v_exp_f32 v115, v115
    v_cvt_pk_bf16_f32 v152, v112, v113
    v_exp_f32 v116, v116
    v_cvt_pk_bf16_f32 v153, v114, v115
    v_exp_f32 v117, v117
    v_exp_f32 v118, v118
    v_cvt_pk_bf16_f32 v154, v116, v117
    s_load_dword s75, s[92:93], 0
    s_load_dword s75, s[92:93], 64
    s_load_dword s75, s[92:93], 128
    buffer_load_dwordx4 a[100:103], v1, s[40:43], s12 offen offset:1024 sc1
    buffer_load_dwordx4 a[136:139], v160, s[40:43], s14 offen offset:1152 sc1
    v_exp_f32 v119, v119
    v_exp_f32 v120, v120
    v_cvt_pk_bf16_f32 v155, v118, v119
    v_exp_f32 v121, v121
    v_exp_f32 v122, v122
    v_mfma_f32_32x32x16_bf16 v[224:239], a[64:67], v[152:155], 0
    v_exp_f32 v123, v123
    v_cvt_pk_bf16_f32 v156, v120, v121
    v_exp_f32 v124, v124
    v_exp_f32 v125, v125
    v_cvt_pk_bf16_f32 v157, v122, v123
    s_load_dword s75, s[92:93], 192
    s_load_dword s75, s[92:93], 256
    s_load_dword s75, s[92:93], 320
    buffer_load_dwordx4 a[140:143], v161, s[40:43], s14 offen offset:1152 sc1
    v_exp_f32 v126, v126
    v_exp_f32 v127, v127
    v_cvt_pk_bf16_f32 v158, v124, v125
    v_cvt_pk_bf16_f32 v159, v126, v127
    v_mfma_f32_32x32x16_bf16 v[112:127], a[20:23], v[60:63], 0
    v_exp_f32 v96, v96
    v_exp_f32 v97, v97
    v_exp_f32 v98, v98
    v_mfma_f32_32x32x16_bf16 v[224:239], a[68:71], v[156:159], v[224:239]
    v_exp_f32 v99, v99
    v_cvt_pk_bf16_f32 v144, v96, v97
    v_exp_f32 v100, v100
    v_cvt_pk_bf16_f32 v145, v98, v99
    v_exp_f32 v101, v101
    v_exp_f32 v102, v102
    v_cvt_pk_bf16_f32 v146, v100, v101
    s_load_dword s75, s[92:93], 384
    s_load_dword s75, s[92:93], 448
L_stubhead_2:
L_stub_2:
    s_cbranch_execz L_stub_6
    s_load_dword s75, s[92:93], 512
    buffer_load_dwordx4 a[104:107], v1, s[40:43], s12 offen offset:2048 sc1
    buffer_load_dwordx4 a[144:147], v160, s[40:43], s14 offen offset:2304 sc1
    v_exp_f32 v103, v103
    v_exp_f32 v104, v104
    v_cvt_pk_bf16_f32 v147, v102, v103
    v_exp_f32 v105, v105
    v_exp_f32 v106, v106
    v_mfma_f32_32x32x16_bf16 v[240:255], a[64:67], v[144:147], 0
    v_exp_f32 v107, v107
    v_cvt_pk_bf16_f32 v148, v104, v105
    v_exp_f32 v108, v108
    v_exp_f32 v109, v109
    v_cvt_pk_bf16_f32 v149, v106, v107
    s_load_dword s75, s[92:93], 576
    s_load_dword s75, s[92:93], 640
    s_load_dword s75, s[92:93], 704
    buffer_load_dwordx4 a[148:151], v161, s[40:43], s14 offen offset:2304 sc1
    v_exp_f32 v110, v110
    v_exp_f32 v111, v111
    v_cvt_pk_bf16_f32 v150, v108, v109
    v_cvt_pk_bf16_f32 v151, v110, v111
    v_mfma_f32_32x32x16_bf16 v[96:111], a[24:27], v[60:63], 0
    v_exp_f32 v112, v112
    v_exp_f32 v113, v113
    v_exp_f32 v114, v114
    v_mfma_f32_32x32x16_bf16 v[240:255], a[68:71], v[148:151], v[240:255]
    v_exp_f32 v115, v115
    v_cvt_pk_bf16_f32 v152, v112, v113
    v_exp_f32 v116, v116
    v_cvt_pk_bf16_f32 v153, v114, v115
    v_exp_f32 v117, v117
    v_exp_f32 v118, v118
    v_cvt_pk_bf16_f32 v154, v116, v117
    s_load_dword s75, s[92:93], 768
    s_load_dword s75, s[92:93], 832
    s_load_dword s75, s[92:93], 896
    buffer_load_dwordx4 a[108:111], v1, s[40:43], s12 offen offset:3072 sc1
    buffer_load_dwordx4 a[152:155], v160, s[40:43], s14 offen offset:3456 sc1
    v_exp_f32 v119, v119
    v_exp_f32 v120, v120
    v_cvt_pk_bf16_f32 v155, v118, v119
    v_exp_f32 v121, v121
    v_exp_f32 v122, v122
    v_mfma_f32_32x32x16_bf16 v[240:255], a[72:75], v[152:155], v[240:255]
    v_exp_f32 v123, v123
    v_cvt_pk_bf16_f32 v156, v120, v121
    v_exp_f32 v124, v124
    v_exp_f32 v125, v125
    v_cvt_pk_bf16_f32 v157, v122, v123
    s_load_dword s75, s[92:93], 960
    s_lshr_b32 s76, s2, 3
    s_lshl_b32 s76, s76, 2
    buffer_load_dwordx4 a[156:159], v161, s[40:43], s14 offen offset:3456 sc1
    v_exp_f32 v126, v126
    v_exp_f32 v127, v127
    v_cvt_pk_bf16_f32 v158, v124, v125
    v_cvt_pk_bf16_f32 v159, v126, v127
    v_mfma_f32_32x32x16_bf16 v[112:127], a[28:31], v[60:63], v[64:79]
    v_exp_f32 v96, v96
    v_exp_f32 v97, v97
    v_exp_f32 v98, v98
    v_mfma_f32_32x32x16_bf16 v[240:255], a[76:79], v[156:159], v[240:255]
    v_exp_f32 v99, v99
    v_cvt_pk_bf16_f32 v144, v96, v97
    v_exp_f32 v100, v100
    v_cvt_pk_bf16_f32 v145, v98, v99
    v_exp_f32 v101, v101
    v_exp_f32 v102, v102
    v_cvt_pk_bf16_f32 v146, v100, v101
    s_add_u32 s76, s76, s68
    s_and_b32 s77, s76, 63
    s_lshl_b32 s77, s77, 13
    buffer_load_dwordx4 a[112:115], v1, s[36:39], s13 offen offset:0 sc1
    buffer_load_dwordx4 a[160:163], v160, s[36:39], s15 offen offset:0 sc1
    v_exp_f32 v103, v103
    v_exp_f32 v104, v104
    v_cvt_pk_bf16_f32 v147, v102, v103
    v_exp_f32 v105, v105
    v_exp_f32 v106, v106
    v_mfma_f32_32x32x16_bf16 v[240:255], a[80:83], v[144:147], v[240:255]
    v_exp_f32 v107, v107
    v_cvt_pk_bf16_f32 v148, v104, v105
    v_exp_f32 v108, v108
    v_exp_f32 v109, v109
    v_cvt_pk_bf16_f32 v149, v106, v107
    s_cmp_lt_u32 s76, 64
    s_cselect_b32 s92, s44, s48
    s_cselect_b32 s93, s45, s49
    s_add_u32 s92, s92, s77
    s_addc_u32 s93, s93, 0
    s_load_dword s75, s[92:93], 384
    buffer_load_dwordx4 a[164:167], v161, s[36:39], s15 offen offset:0 sc1
    v_exp_f32 v110, v110
    v_exp_f32 v111, v111
    v_cvt_pk_bf16_f32 v150, v108, v109
    v_cvt_pk_bf16_f32 v151, v110, v111
    s_waitcnt vmcnt(12)
    v_mfma_f32_32x32x16_bf16 v[96:111], a[96:99], v[48:51], v[80:95]
    v_exp_f32 v112, v112
    v_exp_f32 v113, v113
    v_exp_f32 v114, v114
    v_mfma_f32_32x32x16_bf16 v[240:255], a[84:87], v[148:151], v[240:255]
    v_exp_f32 v115, v115
    v_cvt_pk_bf16_f32 v152, v112, v113
    v_exp_f32 v116, v116
    v_cvt_pk_bf16_f32 v153, v114, v115
    v_exp_f32 v117, v117
    v_exp_f32 v118, v118
    v_cvt_pk_bf16_f32 v154, v116, v117
    s_load_dword s75, s[92:93], 448
    s_load_dword s75, s[92:93], 1408
    s_load_dword s75, s[92:93], 1472
    buffer_load_dwordx4 a[116:119], v1, s[36:39], s13 offen offset:1024 sc1
    buffer_load_dwordx4 a[168:171], v160, s[36:39], s15 offen offset:1152 sc1
    v_exp_f32 v119, v119
    v_exp_f32 v120, v120
    v_cvt_pk_bf16_f32 v155, v118, v119
    v_exp_f32 v121, v121
    v_exp_f32 v122, v122
    v_mfma_f32_32x32x16_bf16 v[240:255], a[88:91], v[152:155], v[240:255]
    v_exp_f32 v123, v123
    v_cvt_pk_bf16_f32 v156, v120, v121
    v_exp_f32 v124, v124
    v_exp_f32 v125, v125
    v_cvt_pk_bf16_f32 v157, v122, v123
    s_load_dword s75, s[92:93], 2432
    s_load_dword s75, s[92:93], 2496
    s_load_dword s75, s[92:93], 3456
    buffer_load_dwordx4 a[172:175], v161, s[36:39], s15 offen offset:1152 sc1
    v_exp_f32 v126, v126
    v_exp_f32 v127, v127
    v_cvt_pk_bf16_f32 v158, v124, v125
    v_cvt_pk_bf16_f32 v159, v126, v127
    s_waitcnt vmcnt(12)
    v_mfma_f32_32x32x16_bf16 v[112:127], a[100:103], v[48:51], 0
    v_exp_f32 v96, v96
    v_exp_f32 v97, v97
    v_exp_f32 v98, v98
    v_mfma_f32_32x32x16_bf16 v[240:255], a[92:95], v[156:159], v[240:255]
    v_exp_f32 v99, v99
    v_cvt_pk_bf16_f32 v144, v96, v97
    v_exp_f32 v100, v100
    v_cvt_pk_bf16_f32 v145, v98, v99
    v_exp_f32 v101, v101
    v_exp_f32 v102, v102
    v_cvt_pk_bf16_f32 v146, v100, v101
    s_load_dword s75, s[92:93], 3520
    s_load_dword s75, s[92:93], 4480
    s_load_dword s75, s[92:93], 4544
    buffer_load_dwordx4 a[120:123], v1, s[36:39], s13 offen offset:2048 sc1
    buffer_load_dwordx4 a[176:179], v160, s[36:39], s15 offen offset:2304 sc1
    v_exp_f32 v103, v103
    v_exp_f32 v104, v104
    v_cvt_pk_bf16_f32 v147, v102, v103
    v_exp_f32 v105, v105
    v_exp_f32 v106, v106
    v_mfma_f32_32x32x16_bf16 v[192:207], a[128:131], v[144:147], v[192:207]
    v_exp_f32 v107, v107
    v_cvt_pk_bf16_f32 v148, v104, v105
    v_exp_f32 v108, v108
    v_exp_f32 v109, v109
    v_cvt_pk_bf16_f32 v149, v106, v107
    s_load_dword s75, s[92:93], 5504
    s_load_dword s75, s[92:93], 5568
    s_load_dword s75, s[92:93], 6528
    buffer_load_dwordx4 a[180:183], v161, s[36:39], s15 offen offset:2304 sc1
    v_exp_f32 v110, v110
    v_exp_f32 v111, v111
    v_cvt_pk_bf16_f32 v150, v108, v109
    v_cvt_pk_bf16_f32 v151, v110, v111
    s_waitcnt vmcnt(12)
    v_mfma_f32_32x32x16_bf16 v[96:111], a[104:107], v[48:51], 0
    v_exp_f32 v112, v112
    v_exp_f32 v113, v113
    v_exp_f32 v114, v114
    v_mfma_f32_32x32x16_bf16 v[192:207], a[132:135], v[148:151], v[192:207]
    v_exp_f32 v115, v115
    v_cvt_pk_bf16_f32 v152, v112, v113
    v_exp_f32 v116, v116
    v_cvt_pk_bf16_f32 v153, v114, v115
    v_exp_f32 v117, v117
    v_exp_f32 v118, v118
    v_cvt_pk_bf16_f32 v154, v116, v117
    s_load_dword s75, s[92:93], 6592
    s_load_dword s75, s[92:93], 7552
    s_load_dword s75, s[92:93], 7616
    buffer_load_dwordx4 a[124:127], v1, s[36:39], s13 offen offset:3072 sc1
    buffer_load_dwordx4 a[184:187], v160, s[36:39], s15 offen offset:3456 sc1
    v_exp_f32 v119, v119
    v_exp_f32 v120, v120
    v_cvt_pk_bf16_f32 v155, v118, v119
    v_exp_f32 v121, v121
    v_exp_f32 v122, v122
    v_mfma_f32_32x32x16_bf16 v[192:207], a[136:139], v[152:155], v[192:207]
    v_exp_f32 v123, v123
    v_cvt_pk_bf16_f32 v156, v120, v121
    v_exp_f32 v124, v124
    v_exp_f32 v125, v125
    v_cvt_pk_bf16_f32 v157, v122, v123
    buffer_load_dwordx4 a[188:191], v161, s[36:39], s15 offen offset:3456 sc1
    v_exp_f32 v126, v126
    v_exp_f32 v127, v127
    v_cvt_pk_bf16_f32 v158, v124, v125
    v_cvt_pk_bf16_f32 v159, v126, v127
    s_waitcnt vmcnt(12)
    v_mfma_f32_32x32x16_bf16 v[112:127], a[108:111], v[48:51], 0
    v_exp_f32 v96, v96
    v_exp_f32 v97, v97
    v_exp_f32 v98, v98
    v_mfma_f32_32x32x16_bf16 v[192:207], a[140:143], v[156:159], v[192:207]
    v_exp_f32 v99, v99
    v_cvt_pk_bf16_f32 v144, v96, v97
    v_exp_f32 v100, v100
    v_cvt_pk_bf16_f32 v145, v98, v99
    v_exp_f32 v101, v101
    v_exp_f32 v102, v102
    v_cvt_pk_bf16_f32 v146, v100, v101
    buffer_load_dwordx4 a[0:3], v1, s[40:43], s20 offen offset:0 sc1
    buffer_load_dwordx4 a[32:35], v160, s[40:43], s22 offen offset:0 sc1
    v_exp_f32 v103, v103
    v_exp_f32 v104, v104
    v_cvt_pk_bf16_f32 v147, v102, v103
    v_exp_f32 v105, v105
    v_exp_f32 v106, v106
    v_mfma_f32_32x32x16_bf16 v[192:207], a[144:147], v[144:147], v[192:207]
    v_exp_f32 v107, v107
    v_cvt_pk_bf16_f32 v148, v104, v105
    v_exp_f32 v108, v108
    v_exp_f32 v109, v109
    v_cvt_pk_bf16_f32 v149, v106, v107
    buffer_load_dwordx4 a[36:39], v161, s[40:43], s22 offen offset:0 sc1
    v_exp_f32 v110, v110
    v_exp_f32 v111, v111
    v_cvt_pk_bf16_f32 v150, v108, v109
    v_cvt_pk_bf16_f32 v151, v110, v111
    v_mfma_f32_32x32x16_bf16 v[96:111], a[108:111], v[52:55], v[80:95]
    v_exp_f32 v112, v112
    v_exp_f32 v113, v113
    v_exp_f32 v114, v114
    v_mfma_f32_32x32x16_bf16 v[192:207], a[148:151], v[148:151], v[192:207]
    v_exp_f32 v115, v115
    v_cvt_pk_bf16_f32 v152, v112, v113
    v_exp_f32 v116, v116
    v_cvt_pk_bf16_f32 v153, v114, v115
    v_exp_f32 v117, v117
    v_exp_f32 v118, v118
    v_cvt_pk_bf16_f32 v154, v116, v117
    buffer_load_dwordx4 a[4:7], v1, s[40:43], s20 offen offset:1024 sc1
    buffer_load_dwordx4 a[40:43], v160, s[40:43], s22 offen offset:1152 sc1
    v_exp_f32 v119, v119
    v_exp_f32 v120, v120
    v_cvt_pk_bf16_f32 v155, v118, v119
    v_exp_f32 v121, v121
    v_exp_f32 v122, v122
    v_mfma_f32_32x32x16_bf16 v[192:207], a[152:155], v[152:155], v[192:207]
    v_exp_f32 v123, v123
    v_cvt_pk_bf16_f32 v156, v120, v121
    v_exp_f32 v124, v124
    v_exp_f32 v125, v125
    v_cvt_pk_bf16_f32 v157, v122, v123
    buffer_load_dwordx4 a[44:47], v161, s[40:43], s22 offen offset:1152 sc1
    v_exp_f32 v126, v126
    v_exp_f32 v127, v127
    v_cvt_pk_bf16_f32 v158, v124, v125
    v_cvt_pk_bf16_f32 v159, v126, v127
    s_waitcnt vmcnt(15)
    v_mfma_f32_32x32x16_bf16 v[112:127], a[112:115], v[48:51], 0
    v_exp_f32 v96, v96
    v_exp_f32 v97, v97
    v_exp_f32 v98, v98
    v_mfma_f32_32x32x16_bf16 v[192:207], a[156:159], v[156:159], v[192:207]
    v_exp_f32 v99, v99
    v_cvt_pk_bf16_f32 v144, v96, v97
    v_exp_f32 v100, v100
    v_cvt_pk_bf16_f32 v145, v98, v99
    v_exp_f32 v101, v101
    v_exp_f32 v102, v102
    v_cvt_pk_bf16_f32 v146, v100, v101
    buffer_load_dwordx4 a[8:11], v1, s[40:43], s20 offen offset:2048 sc1
    buffer_load_dwordx4 a[48:51], v160, s[40:43], s22 offen offset:2304 sc1
    v_exp_f32 v103, v103
    v_exp_f32 v104, v104
    v_cvt_pk_bf16_f32 v147, v102, v103
    v_exp_f32 v105, v105
    v_exp_f32 v106, v106
    v_mfma_f32_32x32x16_bf16 v[208:223], a[152:155], v[144:147], v[208:223]
    v_exp_f32 v107, v107
    v_cvt_pk_bf16_f32 v148, v104, v105
    v_exp_f32 v108, v108
    v_exp_f32 v109, v109
    v_cvt_pk_bf16_f32 v149, v106, v107
    buffer_load_dwordx4 a[52:55], v161, s[40:43], s22 offen offset:2304 sc1
    v_exp_f32 v110, v110
    v_exp_f32 v111, v111
    v_cvt_pk_bf16_f32 v150, v108, v109
    v_cvt_pk_bf16_f32 v151, v110, v111
    v_mfma_f32_32x32x16_bf16 v[96:111], a[112:115], v[52:55], 0
    v_exp_f32 v112, v112
    v_exp_f32 v113, v113
    v_exp_f32 v114, v114
    v_mfma_f32_32x32x16_bf16 v[208:223], a[156:159], v[148:151], v[208:223]
    v_exp_f32 v115, v115
    v_cvt_pk_bf16_f32 v152, v112, v113
    v_exp_f32 v116, v116
    v_cvt_pk_bf16_f32 v153, v114, v115
    v_exp_f32 v117, v117
    v_exp_f32 v118, v118
    v_cvt_pk_bf16_f32 v154, v116, v117
    buffer_load_dwordx4 a[12:15], v1, s[40:43], s20 offen offset:3072 sc1
    buffer_load_dwordx4 a[56:59], v160, s[40:43], s22 offen offset:3456 sc1
    v_exp_f32 v119, v119
    v_exp_f32 v120, v120
    v_cvt_pk_bf16_f32 v155, v118, v119
    v_exp_f32 v121, v121
    v_exp_f32 v122, v122
    v_mfma_f32_32x32x16_bf16 v[192:207], a[160:163], v[152:155], v[192:207]
    v_exp_f32 v123, v123
    v_cvt_pk_bf16_f32 v156, v120, v121
    v_exp_f32 v124, v124
    v_exp_f32 v125, v125
    v_cvt_pk_bf16_f32 v157, v122, v123
    buffer_load_dwordx4 a[60:63], v161, s[40:43], s22 offen offset:3456 sc1
    v_exp_f32 v126, v126
    v_exp_f32 v127, v127
    v_cvt_pk_bf16_f32 v158, v124, v125
    v_cvt_pk_bf16_f32 v159, v126, v127
    s_waitcnt vmcnt(18)
    v_mfma_f32_32x32x16_bf16 v[112:127], a[116:119], v[48:51], 0
    v_exp_f32 v96, v96
    v_exp_f32 v97, v97
    v_exp_f32 v98, v98
    v_mfma_f32_32x32x16_bf16 v[192:207], a[164:167], v[156:159], v[192:207]
    v_exp_f32 v99, v99
    v_cvt_pk_bf16_f32 v144, v96, v97
    v_exp_f32 v100, v100
    v_cvt_pk_bf16_f32 v145, v98, v99
    v_exp_f32 v101, v101
    v_exp_f32 v102, v102
    v_cvt_pk_bf16_f32 v146, v100, v101
    buffer_load_dwordx4 a[16:19], v1, s[36:39], s21 offen offset:0 sc1
    buffer_load_dwordx4 a[64:67], v160, s[36:39], s23 offen offset:0 sc1
    v_exp_f32 v103, v103
    v_exp_f32 v104, v104
    v_cvt_pk_bf16_f32 v147, v102, v103
    v_exp_f32 v105, v105
    v_exp_f32 v106, v106
    v_mfma_f32_32x32x16_bf16 v[208:223], a[160:163], v[144:147], v[208:223]
    v_exp_f32 v107, v107
    v_cvt_pk_bf16_f32 v148, v104, v105
    v_exp_f32 v108, v108
    v_exp_f32 v109, v109
    v_cvt_pk_bf16_f32 v149, v106, v107
    buffer_load_dwordx4 a[68:71], v161, s[36:39], s23 offen offset:0 sc1
    v_exp_f32 v110, v110
    v_exp_f32 v111, v111
    v_cvt_pk_bf16_f32 v150, v108, v109
    v_cvt_pk_bf16_f32 v151, v110, v111
    v_mfma_f32_32x32x16_bf16 v[96:111], a[116:119], v[52:55], 0
    v_exp_f32 v112, v112
    v_exp_f32 v113, v113
    v_exp_f32 v114, v114
    v_mfma_f32_32x32x16_bf16 v[208:223], a[164:167], v[148:151], v[208:223]
    v_exp_f32 v115, v115
    v_cvt_pk_bf16_f32 v152, v112, v113
    v_exp_f32 v116, v116
    v_cvt_pk_bf16_f32 v153, v114, v115
    v_exp_f32 v117, v117
    v_exp_f32 v118, v118
    v_cvt_pk_bf16_f32 v154, v116, v117
    buffer_load_dwordx4 a[20:23], v1, s[36:39], s21 offen offset:1024 sc1
    buffer_load_dwordx4 a[72:75], v160, s[36:39], s23 offen offset:1152 sc1
    v_exp_f32 v119, v119
    v_exp_f32 v120, v120
    v_cvt_pk_bf16_f32 v155, v118, v119
    v_exp_f32 v121, v121
    v_exp_f32 v122, v122
    v_mfma_f32_32x32x16_bf16 v[192:207], a[168:171], v[152:155], v[192:207]
    v_exp_f32 v123, v123
    v_cvt_pk_bf16_f32 v156, v120, v121
    v_exp_f32 v124, v124
    v_exp_f32 v125, v125
    v_cvt_pk_bf16_f32 v157, v122, v123
    buffer_load_dwordx4 a[76:79], v161, s[36:39], s23 offen offset:1152 sc1
    v_exp_f32 v126, v126
    v_exp_f32 v127, v127
    v_cvt_pk_bf16_f32 v158, v124, v125
    v_cvt_pk_bf16_f32 v159, v126, v127
    s_waitcnt vmcnt(21)
    v_mfma_f32_32x32x16_bf16 v[112:127], a[120:123], v[48:51], 0
    v_exp_f32 v96, v96
    v_exp_f32 v97, v97
    v_exp_f32 v98, v98
    v_mfma_f32_32x32x16_bf16 v[192:207], a[172:175], v[156:159], v[192:207]
    v_exp_f32 v99, v99
    v_cvt_pk_bf16_f32 v144, v96, v97
    v_exp_f32 v100, v100
    v_cvt_pk_bf16_f32 v145, v98, v99
    v_exp_f32 v101, v101
    v_exp_f32 v102, v102
    v_cvt_pk_bf16_f32 v146, v100, v101
    buffer_load_dwordx4 a[24:27], v1, s[36:39], s21 offen offset:2048 sc1
    buffer_load_dwordx4 a[80:83], v160, s[36:39], s23 offen offset:2304 sc1
    v_exp_f32 v103, v103
    v_exp_f32 v104, v104
    v_cvt_pk_bf16_f32 v147, v102, v103
    v_exp_f32 v105, v105
    v_exp_f32 v106, v106
    v_mfma_f32_32x32x16_bf16 v[208:223], a[168:171], v[144:147], v[208:223]
    v_exp_f32 v107, v107
    v_cvt_pk_bf16_f32 v148, v104, v105
    v_exp_f32 v108, v108
    v_exp_f32 v109, v109
    v_cvt_pk_bf16_f32 v149, v106, v107
    buffer_load_dwordx4 a[84:87], v161, s[36:39], s23 offen offset:2304 sc1
    v_exp_f32 v110, v110
    v_exp_f32 v111, v111
    v_cvt_pk_bf16_f32 v150, v108, v109
    v_cvt_pk_bf16_f32 v151, v110, v111
    v_mfma_f32_32x32x16_bf16 v[96:111], a[120:123], v[52:55], 0
    v_exp_f32 v112, v112
    v_exp_f32 v113, v113
    v_exp_f32 v114, v114
    v_mfma_f32_32x32x16_bf16 v[208:223], a[172:175], v[148:151], v[208:223]
    v_exp_f32 v115, v115
    v_cvt_pk_bf16_f32 v152, v112, v113
    v_exp_f32 v116, v116
    v_cvt_pk_bf16_f32 v153, v114, v115
    v_exp_f32 v117, v117
    v_exp_f32 v118, v118
    v_cvt_pk_bf16_f32 v154, v116, v117
    buffer_load_dwordx4 a[28:31], v1, s[36:39], s21 offen offset:3072 sc1
    buffer_load_dwordx4 a[88:91], v160, s[36:39], s23 offen offset:3456 sc1
    v_exp_f32 v119, v119
    v_exp_f32 v120, v120
    v_cvt_pk_bf16_f32 v155, v118, v119
    v_exp_f32 v121, v121
    v_exp_f32 v122, v122
    v_mfma_f32_32x32x16_bf16 v[192:207], a[176:179], v[152:155], v[192:207]
    v_exp_f32 v123, v123
    v_cvt_pk_bf16_f32 v156, v120, v121
    v_exp_f32 v124, v124
    v_exp_f32 v125, v125
    v_cvt_pk_bf16_f32 v157, v122, v123
    buffer_load_dwordx4 a[92:95], v161, s[36:39], s23 offen offset:3456 sc1
    v_exp_f32 v126, v126
    v_exp_f32 v127, v127
    v_cvt_pk_bf16_f32 v158, v124, v125
    v_cvt_pk_bf16_f32 v159, v126, v127
    s_waitcnt vmcnt(24)
    v_mfma_f32_32x32x16_bf16 v[112:127], a[124:127], v[48:51], 0
    v_exp_f32 v96, v96
    v_exp_f32 v97, v97
    v_exp_f32 v98, v98
    v_mfma_f32_32x32x16_bf16 v[192:207], a[180:183], v[156:159], v[192:207]
    v_exp_f32 v99, v99
    v_cvt_pk_bf16_f32 v144, v96, v97
    v_exp_f32 v100, v100
    v_cvt_pk_bf16_f32 v145, v98, v99
    v_exp_f32 v101, v101
    v_exp_f32 v102, v102
    v_cvt_pk_bf16_f32 v146, v100, v101
    buffer_store_dwordx4 v[24:27], v1, s[32:35], s18 offen sc1
    buffer_store_dwordx4 v[24:27], v1, s[32:35], s19 offen sc1
    s_add_u32 m0, s71, 0x8000
    v_exp_f32 v103, v103
    v_exp_f32 v104, v104
    v_cvt_pk_bf16_f32 v147, v102, v103
    v_exp_f32 v105, v105
    v_exp_f32 v106, v106
    v_mfma_f32_32x32x16_bf16 v[208:223], a[176:179], v[144:147], v[208:223]
    v_exp_f32 v107, v107
    v_cvt_pk_bf16_f32 v148, v104, v105
    v_exp_f32 v108, v108
    v_exp_f32 v109, v109
    v_cvt_pk_bf16_f32 v149, v106, v107
    buffer_load_dwordx4 v172, s[44:47], s11 offen offset:0 lds
    v_exp_f32 v110, v110
    v_exp_f32 v111, v111
    v_cvt_pk_bf16_f32 v150, v108, v109
    v_cvt_pk_bf16_f32 v151, v110, v111
    v_mfma_f32_32x32x16_bf16 v[96:111], a[124:127], v[52:55], 0
    v_exp_f32 v112, v112
    v_exp_f32 v113, v113
    v_exp_f32 v114, v114
    v_mfma_f32_32x32x16_bf16 v[208:223], a[180:183], v[148:151], v[208:223]
    v_exp_f32 v115, v115
    v_cvt_pk_bf16_f32 v152, v112, v113
    v_exp_f32 v116, v116
    v_cvt_pk_bf16_f32 v153, v114, v115
    v_exp_f32 v117, v117
    v_exp_f32 v118, v118
    v_cvt_pk_bf16_f32 v154, v116, v117
    buffer_load_dwordx4 v173, s[44:47], s11 offen offset:1024 lds
    buffer_load_dwordx4 v174, s[44:47], s11 offen offset:2048 lds
    v_exp_f32 v119, v119
    v_exp_f32 v120, v120
    v_cvt_pk_bf16_f32 v155, v118, v119
    v_exp_f32 v121, v121
    v_exp_f32 v122, v122
    v_mfma_f32_32x32x16_bf16 v[192:207], a[184:187], v[152:155], v[192:207]
    v_exp_f32 v123, v123
    v_cvt_pk_bf16_f32 v156, v120, v121
    v_exp_f32 v124, v124
    v_exp_f32 v125, v125
    v_cvt_pk_bf16_f32 v157, v122, v123
    buffer_load_dwordx4 v175, s[44:47], s11 offen offset:3072 lds
    s_add_u32 m0, s71, 0x18000
    v_exp_f32 v126, v126
    v_exp_f32 v127, v127
    v_cvt_pk_bf16_f32 v158, v124, v125
    v_cvt_pk_bf16_f32 v159, v126, v127
    s_waitcnt vmcnt(27)
    v_mfma_f32_32x32x16_bf16 v[112:127], a[0:3], v[56:59], v[80:95]
    v_exp_f32 v96, v96
    v_exp_f32 v97, v97
    v_exp_f32 v98, v98
    v_mfma_f32_32x32x16_bf16 v[192:207], a[188:191], v[156:159], v[192:207]
    v_exp_f32 v99, v99
    v_cvt_pk_bf16_f32 v144, v96, v97
    v_exp_f32 v100, v100
    v_cvt_pk_bf16_f32 v145, v98, v99
    v_exp_f32 v101, v101
    v_exp_f32 v102, v102
    v_cvt_pk_bf16_f32 v146, v100, v101
    buffer_load_dwordx4 v172, s[48:51], s11 offen offset:0 lds
    buffer_load_dwordx4 v173, s[48:51], s11 offen offset:1024 lds
    v_exp_f32 v103, v103
    v_exp_f32 v104, v104
    v_cvt_pk_bf16_f32 v147, v102, v103
    v_exp_f32 v105, v105
    v_exp_f32 v106, v106
    v_mfma_f32_32x32x16_bf16 v[208:223], a[184:187], v[144:147], v[208:223]
    v_exp_f32 v107, v107
    v_cvt_pk_bf16_f32 v148, v104, v105
    v_exp_f32 v108, v108
    v_exp_f32 v109, v109
    v_cvt_pk_bf16_f32 v149, v106, v107
    buffer_load_dwordx4 v174, s[48:51], s11 offen offset:2048 lds
    v_exp_f32 v110, v110
    v_exp_f32 v111, v111
    v_cvt_pk_bf16_f32 v150, v108, v109
    v_cvt_pk_bf16_f32 v151, v110, v111
    s_waitcnt vmcnt(27)
    v_mfma_f32_32x32x16_bf16 v[96:111], a[4:7], v[56:59], 0
    v_exp_f32 v112, v112
    v_exp_f32 v113, v113
    v_exp_f32 v114, v114
    v_mfma_f32_32x32x16_bf16 v[208:223], a[188:191], v[148:151], v[208:223]
    v_exp_f32 v115, v115
    v_cvt_pk_bf16_f32 v152, v112, v113
    v_exp_f32 v116, v116
    v_cvt_pk_bf16_f32 v153, v114, v115
    v_exp_f32 v117, v117
    v_exp_f32 v118, v118
    v_cvt_pk_bf16_f32 v154, v116, v117
    buffer_load_dwordx4 v175, s[48:51], s11 offen offset:3072 lds
    s_add_u32 s85, s11, 131072
    s_add_u32 m0, s71, 0x1c000
    v_exp_f32 v119, v119
    v_exp_f32 v120, v120
    v_cvt_pk_bf16_f32 v155, v118, v119
    v_exp_f32 v121, v121
    v_exp_f32 v122, v122
    v_mfma_f32_32x32x16_bf16 v[224:239], a[32:35], v[152:155], v[224:239]
    v_exp_f32 v123, v123
    v_cvt_pk_bf16_f32 v156, v120, v121
    v_exp_f32 v124, v124
    v_exp_f32 v125, v125
    v_cvt_pk_bf16_f32 v157, v122, v123
    buffer_load_dwordx4 v172, s[48:51], s85 offen offset:0 lds
    v_exp_f32 v126, v126
    v_exp_f32 v127, v127
    v_cvt_pk_bf16_f32 v158, v124, v125
    v_cvt_pk_bf16_f32 v159, v126, v127
    v_pk_mul_f32 v[138:139], v[192:193], v[192:193]
    v_med3_f32 v136, v200, v165, v166
    v_pk_fma_f32 v[138:139], v[194:195], v[194:195], v[138:139]
    v_pk_fma_f32 v[138:139], v[196:197], v[196:197], v[138:139]
    v_pk_fma_f32 v[138:139], v[198:199], v[198:199], v[138:139]
    v_cmp_eq_f32 s[92:93], v136, v200
    v_add_f32 v138, v138, v139
    v_rcp_f32 v136, v200
    v_med3_f32 v139, v138, v167, v168
    v_cmp_eq_f32 vcc, v139, v138
    s_nop 1
    s_and_b64 vcc, vcc, s[92:93]
    s_cmp_eq_u64 vcc, -1
    s_cbranch_scc0 L_fb_7
L_back_6:
    v_pk_mul_f32 v[192:193], v[192:193], v[136:137] op_sel_hi:[1,0]
    v_pk_mul_f32 v[194:195], v[194:195], v[136:137] op_sel_hi:[1,0]
    v_pk_mul_f32 v[196:197], v[196:197], v[136:137] op_sel_hi:[1,0]
    v_pk_mul_f32 v[198:199], v[198:199], v[136:137] op_sel_hi:[1,0]
    v_cvt_pk_bf16_f32 v128, v192, v193
    v_cvt_pk_bf16_f32 v129, v194, v195
    v_cvt_pk_bf16_f32 v130, v196, v197
    v_cvt_pk_bf16_f32 v131, v198, v199
    buffer_store_dwordx4 v[128:131], v1, s[32:35], s16 offen sc1
    v_pk_mul_f32 v[138:139], v[208:209], v[208:209]
    v_med3_f32 v136, v216, v165, v166
    v_pk_fma_f32 v[138:139], v[210:211], v[210:211], v[138:139]
    v_pk_fma_f32 v[138:139], v[212:213], v[212:213], v[138:139]
    v_pk_fma_f32 v[138:139], v[214:215], v[214:215], v[138:139]
    v_cmp_eq_f32 s[92:93], v136, v216
    v_add_f32 v138, v138, v139
    v_rcp_f32 v136, v216
    v_med3_f32 v139, v138, v167, v168
    v_cmp_eq_f32 vcc, v139, v138
    s_nop 1
    s_and_b64 vcc, vcc, s[92:93]
    s_cmp_eq_u64 vcc, -1
    s_cbranch_scc0 L_fb_9
L_back_8:
    v_pk_mul_f32 v[208:209], v[208:209], v[136:137] op_sel_hi:[1,0]
    v_pk_mul_f32 v[210:211], v[210:211], v[136:137] op_sel_hi:[1,0]
    v_pk_mul_f32 v[212:213], v[212:213], v[136:137] op_sel_hi:[1,0]
    v_pk_mul_f32 v[214:215], v[214:215], v[136:137] op_sel_hi:[1,0]
    v_cvt_pk_bf16_f32 v132, v208, v209
    v_cvt_pk_bf16_f32 v133, v210, v211
    v_cvt_pk_bf16_f32 v134, v212, v213
    v_cvt_pk_bf16_f32 v135, v214, v215
    buffer_store_dwordx4 v[132:135], v1, s[32:35], s17 offen sc1
    s_waitcnt vmcnt(28)
    v_mfma_f32_32x32x16_bf16 v[112:127], a[8:11], v[56:59], 0
    v_exp_f32 v96, v96
    v_exp_f32 v97, v97
    v_exp_f32 v98, v98
    v_mfma_f32_32x32x16_bf16 v[224:239], a[36:39], v[156:159], v[224:239]
    v_exp_f32 v99, v99
    v_cvt_pk_bf16_f32 v144, v96, v97
    v_exp_f32 v100, v100
    v_cvt_pk_bf16_f32 v145, v98, v99
    v_exp_f32 v101, v101
    v_exp_f32 v102, v102
    v_cvt_pk_bf16_f32 v146, v100, v101
    buffer_load_dwordx4 v173, s[48:51], s85 offen offset:1024 lds
    buffer_load_dwordx4 v174, s[48:51], s85 offen offset:2048 lds
    v_exp_f32 v103, v103
    v_exp_f32 v104, v104
    v_cvt_pk_bf16_f32 v147, v102, v103
    v_exp_f32 v105, v105
    v_exp_f32 v106, v106
    v_mfma_f32_32x32x16_bf16 v[224:239], a[40:43], v[144:147], v[224:239]
    v_exp_f32 v107, v107
    v_cvt_pk_bf16_f32 v148, v104, v105
    v_exp_f32 v108, v108
    v_exp_f32 v109, v109
    v_cvt_pk_bf16_f32 v149, v106, v107
    buffer_load_dwordx4 v175, s[48:51], s85 offen offset:3072 lds
    s_add_u32 s85, s11, 262144
    v_exp_f32 v110, v110
    v_exp_f32 v111, v111
    v_cvt_pk_bf16_f32 v150, v108, v109
    v_cvt_pk_bf16_f32 v151, v110, v111
    s_waitcnt vmcnt(28)
    v_mfma_f32_32x32x16_bf16 v[96:111], a[12:15], v[56:59], 0
    v_exp_f32 v112, v112
    v_exp_f32 v113, v113
    v_exp_f32 v114, v114
    v_mfma_f32_32x32x16_bf16 v[224:239], a[44:47], v[148:151], v[224:239]
    v_exp_f32 v115, v115
    v_cvt_pk_bf16_f32 v152, v112, v113
    v_exp_f32 v116, v116
    v_cvt_pk_bf16_f32 v153, v114, v115
    v_exp_f32 v117, v117
    v_exp_f32 v118, v118
    v_cvt_pk_bf16_f32 v154, v116, v117
    s_add_u32 m0, s71, 0x20000
    s_nop 0
    buffer_load_dwordx4 v172, s[48:51], s85 offen offset:0 lds
    buffer_load_dwordx4 v173, s[48:51], s85 offen offset:1024 lds
    v_exp_f32 v119, v119
    v_exp_f32 v120, v120
    v_cvt_pk_bf16_f32 v155, v118, v119
    v_exp_f32 v121, v121
    v_exp_f32 v122, v122
    v_mfma_f32_32x32x16_bf16 v[224:239], a[48:51], v[152:155], v[224:239]
    v_exp_f32 v123, v123
    v_cvt_pk_bf16_f32 v156, v120, v121
    v_exp_f32 v124, v124
    v_exp_f32 v125, v125
    v_cvt_pk_bf16_f32 v157, v122, v123
    buffer_load_dwordx4 v174, s[48:51], s85 offen offset:2048 lds
    v_exp_f32 v126, v126
    v_exp_f32 v127, v127
    v_cvt_pk_bf16_f32 v158, v124, v125
    v_cvt_pk_bf16_f32 v159, v126, v127
    v_mfma_f32_32x32x16_bf16 v[112:127], a[12:15], v[60:63], v[80:95]
L_stubhead_3:
L_stub_3:
    s_cbranch_execz L_stub_7
    v_exp_f32 v96, v96
    v_exp_f32 v97, v97
    v_exp_f32 v98, v98
    v_mfma_f32_32x32x16_bf16 v[224:239], a[52:55], v[156:159], v[224:239]
    v_exp_f32 v99, v99
    v_cvt_pk_bf16_f32 v144, v96, v97
    v_exp_f32 v100, v100
    v_cvt_pk_bf16_f32 v145, v98, v99
    v_exp_f32 v101, v101
    v_exp_f32 v102, v102
    v_cvt_pk_bf16_f32 v146, v100, v101
    buffer_load_dwordx4 v175, s[48:51], s85 offen offset:3072 lds
    s_add_u32 s85, s11, 393216
    s_add_u32 m0, s71, 0x24000
    v_exp_f32 v103, v103
    v_exp_f32 v104, v104
    v_cvt_pk_bf16_f32 v147, v102, v103
    v_exp_f32 v105, v105
    v_exp_f32 v106, v106
    v_mfma_f32_32x32x16_bf16 v[224:239], a[56:59], v[144:147], v[224:239]
    v_exp_f32 v107, v107
    v_cvt_pk_bf16_f32 v148, v104, v105
    v_exp_f32 v108, v108
    v_exp_f32 v109, v109
    v_cvt_pk_bf16_f32 v149, v106, v107
    buffer_load_dwordx4 v172, s[48:51], s85 offen offset:0 lds
    v_exp_f32 v110, v110
    v_exp_f32 v111, v111
    v_cvt_pk_bf16_f32 v150, v108, v109
    v_cvt_pk_bf16_f32 v151, v110, v111
    s_waitcnt vmcnt(30)
    v_mfma_f32_32x32x16_bf16 v[96:111], a[16:19], v[56:59], 0
    v_exp_f32 v112, v112
    v_exp_f32 v113, v113
    v_exp_f32 v114, v114
    v_mfma_f32_32x32x16_bf16 v[224:239], a[60:63], v[148:151], v[224:239]
    v_exp_f32 v115, v115
    v_cvt_pk_bf16_f32 v152, v112, v113
    v_exp_f32 v116, v116
    v_cvt_pk_bf16_f32 v153, v114, v115
    v_exp_f32 v117, v117
    v_exp_f32 v118, v118
    v_cvt_pk_bf16_f32 v154, v116, v117
    buffer_load_dwordx4 v173, s[48:51], s85 offen offset:1024 lds
    buffer_load_dwordx4 v174, s[48:51], s85 offen offset:2048 lds
    v_exp_f32 v119, v119
    v_exp_f32 v120, v120
    v_cvt_pk_bf16_f32 v155, v118, v119
    v_exp_f32 v121, v121
    v_exp_f32 v122, v122
    v_mfma_f32_32x32x16_bf16 v[240:255], a[56:59], v[152:155], v[240:255]
    v_exp_f32 v123, v123
    v_cvt_pk_bf16_f32 v156, v120, v121
    v_exp_f32 v124, v124
    v_exp_f32 v125, v125
    v_cvt_pk_bf16_f32 v157, v122, v123
    buffer_load_dwordx4 v175, s[48:51], s85 offen offset:3072 lds
    s_add_u32 s85, s11, 131072
    v_exp_f32 v126, v126
    v_exp_f32 v127, v127
    v_cvt_pk_bf16_f32 v158, v124, v125
    v_cvt_pk_bf16_f32 v159, v126, v127
    v_mfma_f32_32x32x16_bf16 v[112:127], a[16:19], v[60:63], 0
    v_exp_f32 v96, v96
    v_exp_f32 v97, v97
    v_exp_f32 v98, v98
    v_mfma_f32_32x32x16_bf16 v[240:255], a[60:63], v[156:159], v[240:255]
    v_exp_f32 v99, v99
    v_cvt_pk_bf16_f32 v144, v96, v97
    v_exp_f32 v100, v100
    v_cvt_pk_bf16_f32 v145, v98, v99
    v_exp_f32 v101, v101
    v_exp_f32 v102, v102
    v_cvt_pk_bf16_f32 v146, v100, v101
    s_add_u32 m0, s71, 0xc000
    s_nop 0
    buffer_load_dwordx4 v172, s[44:47], s85 offen offset:0 lds
    buffer_load_dwordx4 v173, s[44:47], s85 offen offset:1024 lds
    v_exp_f32 v103, v103
    v_exp_f32 v104, v104
    v_cvt_pk_bf16_f32 v147, v102, v103
    v_exp_f32 v105, v105
    v_exp_f32 v106, v106
    v_mfma_f32_32x32x16_bf16 v[224:239], a[64:67], v[144:147], v[224:239]
    v_exp_f32 v107, v107
    v_cvt_pk_bf16_f32 v148, v104, v105
    v_exp_f32 v108, v108
    v_exp_f32 v109, v109
    v_cvt_pk_bf16_f32 v149, v106, v107
    buffer_load_dwordx4 v174, s[44:47], s85 offen offset:2048 lds
    v_exp_f32 v110, v110
    v_exp_f32 v111, v111
    v_cvt_pk_bf16_f32 v150, v108, v109
    v_cvt_pk_bf16_f32 v151, v110, v111
    s_waitcnt vmcnt(14)
    buffer_store_dword v30, v31, s[32:35], 0 offen offset:128 sc1
    v_mfma_f32_32x32x16_bf16 v[96:111], a[20:23], v[56:59], 0
    v_exp_f32 v112, v112
    v_exp_f32 v113, v113
    v_exp_f32 v114, v114
    v_mfma_f32_32x32x16_bf16 v[224:239], a[68:71], v[148:151], v[224:239]
    v_exp_f32 v115, v115
    v_cvt_pk_bf16_f32 v152, v112, v113
    v_exp_f32 v116, v116
    v_cvt_pk_bf16_f32 v153, v114, v115
    v_exp_f32 v117, v117
    v_exp_f32 v118, v118
    v_cvt_pk_bf16_f32 v154, v116, v117
    buffer_load_dwordx4 v175, s[44:47], s85 offen offset:3072 lds
    s_add_u32 s85, s11, 262144
    s_add_u32 m0, s71, 0x10000
    v_exp_f32 v119, v119
    v_exp_f32 v120, v120
    v_cvt_pk_bf16_f32 v155, v118, v119
    v_exp_f32 v121, v121
    v_exp_f32 v122, v122
    v_mfma_f32_32x32x16_bf16 v[240:255], a[64:67], v[152:155], v[240:255]
    v_exp_f32 v123, v123
    v_cvt_pk_bf16_f32 v156, v120, v121
    v_exp_f32 v124, v124
    v_exp_f32 v125, v125
    v_cvt_pk_bf16_f32 v157, v122, v123
    buffer_load_dwordx4 v172, s[44:47], s85 offen offset:0 lds
    v_exp_f32 v126, v126
    v_exp_f32 v127, v127
    v_cvt_pk_bf16_f32 v158, v124, v125
    v_cvt_pk_bf16_f32 v159, v126, v127
    v_mfma_f32_32x32x16_bf16 v[112:127], a[20:23], v[60:63], 0
    v_exp_f32 v96, v96
    v_exp_f32 v97, v97
    v_exp_f32 v98, v98
    v_mfma_f32_32x32x16_bf16 v[240:255], a[68:71], v[156:159], v[240:255]
    v_exp_f32 v99, v99
    v_cvt_pk_bf16_f32 v144, v96, v97
    v_exp_f32 v100, v100
    v_cvt_pk_bf16_f32 v145, v98, v99
    v_exp_f32 v101, v101
    v_exp_f32 v102, v102
    v_cvt_pk_bf16_f32 v146, v100, v101
    buffer_load_dwordx4 v173, s[44:47], s85 offen offset:1024 lds
    buffer_load_dwordx4 v174, s[44:47], s85 offen offset:2048 lds
    v_exp_f32 v103, v103
    v_exp_f32 v104, v104
    v_cvt_pk_bf16_f32 v147, v102, v103
    v_exp_f32 v105, v105
    v_exp_f32 v106, v106
    v_mfma_f32_32x32x16_bf16 v[224:239], a[72:75], v[144:147], v[224:239]
    v_exp_f32 v107, v107
    v_cvt_pk_bf16_f32 v148, v104, v105
    v_exp_f32 v108, v108
    v_exp_f32 v109, v109
    v_cvt_pk_bf16_f32 v149, v106, v107
    buffer_load_dwordx4 v175, s[44:47], s85 offen offset:3072 lds
    s_add_u32 s85, s11, 393216
    v_exp_f32 v110, v110
    v_exp_f32 v111, v111
    v_cvt_pk_bf16_f32 v150, v108, v109
    v_cvt_pk_bf16_f32 v151, v110, v111
    v_mfma_f32_32x32x16_bf16 v[96:111], a[24:27], v[56:59], 0
    v_exp_f32 v112, v112
    v_exp_f32 v113, v113
    v_exp_f32 v114, v114
    v_mfma_f32_32x32x16_bf16 v[224:239], a[76:79], v[148:151], v[224:239]
    v_exp_f32 v115, v115
    v_cvt_pk_bf16_f32 v152, v112, v113
    v_exp_f32 v116, v116
    v_cvt_pk_bf16_f32 v153, v114, v115
    v_exp_f32 v117, v117
    v_exp_f32 v118, v118
    v_cvt_pk_bf16_f32 v154, v116, v117
    s_add_u32 m0, s71, 0x14000
    s_nop 0
    buffer_load_dwordx4 v172, s[44:47], s85 offen offset:0 lds
    buffer_load_dwordx4 v173, s[44:47], s85 offen offset:1024 lds
    v_exp_f32 v119, v119
    v_exp_f32 v120, v120
    v_cvt_pk_bf16_f32 v155, v118, v119
    v_exp_f32 v121, v121
    v_exp_f32 v122, v122
    v_mfma_f32_32x32x16_bf16 v[240:255], a[72:75], v[152:155], v[240:255]
    v_exp_f32 v123, v123
    v_cvt_pk_bf16_f32 v156, v120, v121
    v_exp_f32 v124, v124
    v_exp_f32 v125, v125
    v_cvt_pk_bf16_f32 v157, v122, v123
    buffer_load_dwordx4 v174, s[44:47], s85 offen offset:2048 lds
    v_exp_f32 v126, v126
    v_exp_f32 v127, v127
    v_cvt_pk_bf16_f32 v158, v124, v125
    v_cvt_pk_bf16_f32 v159, v126, v127
    v_mfma_f32_32x32x16_bf16 v[112:127], a[24:27], v[60:63], 0
    v_exp_f32 v96, v96
    v_exp_f32 v97, v97
    v_exp_f32 v98, v98
    v_mfma_f32_32x32x16_bf16 v[240:255], a[76:79], v[156:159], v[240:255]
    v_exp_f32 v99, v99
    v_cvt_pk_bf16_f32 v144, v96, v97
    v_exp_f32 v100, v100
    v_cvt_pk_bf16_f32 v145, v98, v99
    v_exp_f32 v101, v101
    v_exp_f32 v102, v102
    v_cvt_pk_bf16_f32 v146, v100, v101
    buffer_load_dwordx4 v175, s[44:47], s85 offen offset:3072 lds
    v_exp_f32 v103, v103
    v_exp_f32 v104, v104
    v_cvt_pk_bf16_f32 v147, v102, v103
    v_exp_f32 v105, v105
    v_exp_f32 v106, v106
    v_mfma_f32_32x32x16_bf16 v[224:239], a[80:83], v[144:147], v[224:239]
    v_exp_f32 v107, v107
    v_cvt_pk_bf16_f32 v148, v104, v105
    v_exp_f32 v108, v108
    v_exp_f32 v109, v109
    v_cvt_pk_bf16_f32 v149, v106, v107
    v_exp_f32 v110, v110
    v_exp_f32 v111, v111
    v_cvt_pk_bf16_f32 v150, v108, v109
    v_cvt_pk_bf16_f32 v151, v110, v111
    v_mfma_f32_32x32x16_bf16 v[96:111], a[28:31], v[56:59], 0
    v_exp_f32 v112, v112
    v_exp_f32 v113, v113
    v_exp_f32 v114, v114
    v_mfma_f32_32x32x16_bf16 v[224:239], a[84:87], v[148:151], v[224:239]
    v_exp_f32 v115, v115
    v_cvt_pk_bf16_f32 v152, v112, v113
    v_exp_f32 v116, v116
    v_cvt_pk_bf16_f32 v153, v114, v115
    v_exp_f32 v117, v117
    v_exp_f32 v118, v118
    v_cvt_pk_bf16_f32 v154, v116, v117
    v_exp_f32 v119, v119
    v_exp_f32 v120, v120
    v_cvt_pk_bf16_f32 v155, v118, v119
    v_exp_f32 v121, v121
    v_exp_f32 v122, v122
    v_mfma_f32_32x32x16_bf16 v[240:255], a[80:83], v[152:155], v[240:255]
    v_exp_f32 v123, v123
    v_cvt_pk_bf16_f32 v156, v120, v121
    v_exp_f32 v124, v124
    v_exp_f32 v125, v125
    v_cvt_pk_bf16_f32 v157, v122, v123
    v_exp_f32 v126, v126
    v_exp_f32 v127, v127
    v_cvt_pk_bf16_f32 v158, v124, v125
    v_cvt_pk_bf16_f32 v159, v126, v127
    v_mfma_f32_32x32x16_bf16 v[112:127], a[28:31], v[60:63], 0
    v_exp_f32 v96, v96
    v_exp_f32 v97, v97
    v_exp_f32 v98, v98
    v_mfma_f32_32x32x16_bf16 v[240:255], a[84:87], v[156:159], v[240:255]
    v_exp_f32 v99, v99
    v_cvt_pk_bf16_f32 v144, v96, v97
    v_exp_f32 v100, v100
    v_cvt_pk_bf16_f32 v145, v98, v99
    v_exp_f32 v101, v101
    v_exp_f32 v102, v102
    v_cvt_pk_bf16_f32 v146, v100, v101
    v_exp_f32 v103, v103
    v_exp_f32 v104, v104
    v_cvt_pk_bf16_f32 v147, v102, v103
    v_exp_f32 v105, v105
    v_exp_f32 v106, v106
    v_mfma_f32_32x32x16_bf16 v[224:239], a[88:91], v[144:147], v[224:239]
    v_exp_f32 v107, v107
    v_cvt_pk_bf16_f32 v148, v104, v105
    v_exp_f32 v108, v108
    v_exp_f32 v109, v109
    v_cvt_pk_bf16_f32 v149, v106, v107
    v_exp_f32 v110, v110
    v_exp_f32 v111, v111
    v_cvt_pk_bf16_f32 v150, v108, v109
    v_cvt_pk_bf16_f32 v151, v110, v111
    v_exp_f32 v112, v112
    v_exp_f32 v113, v113
    v_exp_f32 v114, v114
    v_mfma_f32_32x32x16_bf16 v[224:239], a[92:95], v[148:151], v[224:239]
    v_exp_f32 v115, v115
    v_cvt_pk_bf16_f32 v152, v112, v113
    v_exp_f32 v116, v116
    v_cvt_pk_bf16_f32 v153, v114, v115
    v_exp_f32 v117, v117
    v_exp_f32 v118, v118
    v_cvt_pk_bf16_f32 v154, v116, v117
    v_exp_f32 v119, v119
    v_exp_f32 v120, v120
    v_cvt_pk_bf16_f32 v155, v118, v119
    v_exp_f32 v121, v121
    v_exp_f32 v122, v122
    v_mfma_f32_32x32x16_bf16 v[240:255], a[88:91], v[152:155], v[240:255]
    v_exp_f32 v123, v123
    v_cvt_pk_bf16_f32 v156, v120, v121
    v_exp_f32 v124, v124
    v_exp_f32 v125, v125
    v_cvt_pk_bf16_f32 v157, v122, v123
    v_exp_f32 v126, v126
    v_exp_f32 v127, v127
    v_cvt_pk_bf16_f32 v158, v124, v125
    v_cvt_pk_bf16_f32 v159, v126, v127
    buffer_load_dword v140, v171, s[32:35], 0 offen sc1
    s_nop 0
    v_mfma_f32_32x32x16_bf16 v[240:255], a[92:95], v[156:159], v[240:255]
    v_pk_mul_f32 v[138:139], v[224:225], v[224:225]
    v_med3_f32 v136, v232, v165, v166
    v_pk_fma_f32 v[138:139], v[226:227], v[226:227], v[138:139]
    v_pk_fma_f32 v[138:139], v[228:229], v[228:229], v[138:139]
    v_pk_fma_f32 v[138:139], v[230:231], v[230:231], v[138:139]
    v_cmp_eq_f32 s[92:93], v136, v232
    v_add_f32 v138, v138, v139
    v_rcp_f32 v136, v232
    v_med3_f32 v139, v138, v167, v168
    v_cmp_eq_f32 vcc, v139, v138
    s_nop 1
    s_and_b64 vcc, vcc, s[92:93]
    s_cmp_eq_u64 vcc, -1
    s_cbranch_scc0 L_fb_11
L_back_10:
    v_pk_mul_f32 v[224:225], v[224:225], v[136:137] op_sel_hi:[1,0]
    v_pk_mul_f32 v[226:227], v[226:227], v[136:137] op_sel_hi:[1,0]
    v_pk_mul_f32 v[228:229], v[228:229], v[136:137] op_sel_hi:[1,0]
    v_pk_mul_f32 v[230:231], v[230:231], v[136:137] op_sel_hi:[1,0]
    v_cvt_pk_bf16_f32 v128, v224, v225
    v_cvt_pk_bf16_f32 v129, v226, v227
    v_cvt_pk_bf16_f32 v130, v228, v229
    v_cvt_pk_bf16_f32 v131, v230, v231
    buffer_store_dwordx4 v[128:131], v1, s[32:35], s18 offen sc1
    v_pk_mul_f32 v[138:139], v[240:241], v[240:241]
    v_med3_f32 v136, v248, v165, v166
    v_pk_fma_f32 v[138:139], v[242:243], v[242:243], v[138:139]
    v_pk_fma_f32 v[138:139], v[244:245], v[244:245], v[138:139]
    v_pk_fma_f32 v[138:139], v[246:247], v[246:247], v[138:139]
    v_cmp_eq_f32 s[92:93], v136, v248
    v_add_f32 v138, v138, v139
    v_rcp_f32 v136, v248
    v_med3_f32 v139, v138, v167, v168
    v_cmp_eq_f32 vcc, v139, v138
    s_nop 1
    s_and_b64 vcc, vcc, s[92:93]
    s_cmp_eq_u64 vcc, -1
    s_cbranch_scc0 L_fb_13
L_back_12:
    v_pk_mul_f32 v[240:241], v[240:241], v[136:137] op_sel_hi:[1,0]
    v_pk_mul_f32 v[242:243], v[242:243], v[136:137] op_sel_hi:[1,0]
    v_pk_mul_f32 v[244:245], v[244:245], v[136:137] op_sel_hi:[1,0]
    v_pk_mul_f32 v[246:247], v[246:247], v[136:137] op_sel_hi:[1,0]
    v_cvt_pk_bf16_f32 v132, v240, v241
    v_cvt_pk_bf16_f32 v133, v242, v243
    v_cvt_pk_bf16_f32 v134, v244, v245
    v_cvt_pk_bf16_f32 v135, v246, v247
    buffer_store_dwordx4 v[132:135], v1, s[32:35], s19 offen sc1
    s_branch L_p3
L_wr1:
L_stub_4:
    s_cbranch_execz L_stub_8
    v_mfma_f32_32x32x16_bf16 v[96:111], a[0:3], v[48:51], 0
    s_waitcnt lgkmcnt(2)
    v_mfma_f32_32x32x16_bf16 v[112:127], a[4:7], v[48:51], v[64:79]
    s_nop 9
    v_exp_f32 v96, v96
    v_exp_f32 v97, v97
    v_exp_f32 v98, v98
    v_exp_f32 v99, v99
    v_cvt_pk_bf16_f32 v144, v96, v97
    v_exp_f32 v100, v100
    v_cvt_pk_bf16_f32 v145, v98, v99
    v_exp_f32 v101, v101
    v_exp_f32 v102, v102
    v_cvt_pk_bf16_f32 v146, v100, v101
    ds_read_b128 a[8:11], v162 offset:2048
    ds_read_b128 a[48:51], v163 offset:2080
    ds_read_b128 a[52:55], v164 offset:2080
    v_exp_f32 v103, v103
    v_exp_f32 v104, v104
    v_cvt_pk_bf16_f32 v147, v102, v103
    v_exp_f32 v105, v105
    v_exp_f32 v106, v106
    v_mfma_f32_32x32x16_bf16 v[192:207], a[32:35], v[144:147], 0
    v_exp_f32 v107, v107
    v_cvt_pk_bf16_f32 v148, v104, v105
    v_exp_f32 v108, v108
    v_exp_f32 v109, v109
    v_cvt_pk_bf16_f32 v149, v106, v107
    ds_read_b128 a[16:19], v162 offset:4096
    ds_read_b128 a[64:67], v163 offset:4160
    ds_read_b128 a[68:71], v164 offset:4160
    v_exp_f32 v110, v110
    v_exp_f32 v111, v111
    v_cvt_pk_bf16_f32 v150, v108, v109
    v_cvt_pk_bf16_f32 v151, v110, v111
    v_mfma_f32_32x32x16_bf16 v[96:111], a[0:3], v[52:55], 0
    v_exp_f32 v112, v112
    v_exp_f32 v113, v113
    v_exp_f32 v114, v114
    v_mfma_f32_32x32x16_bf16 v[192:207], a[36:39], v[148:151], v[192:207]
    v_exp_f32 v115, v115
    v_cvt_pk_bf16_f32 v152, v112, v113
    v_exp_f32 v116, v116
    v_cvt_pk_bf16_f32 v153, v114, v115
    v_exp_f32 v117, v117
    v_exp_f32 v118, v118
    v_cvt_pk_bf16_f32 v154, v116, v117
    ds_read_b128 a[20:23], v162 offset:5120
    ds_read_b128 a[72:75], v163 offset:5200
    ds_read_b128 a[76:79], v164 offset:5200
    v_exp_f32 v119, v119
    v_exp_f32 v120, v120
    v_cvt_pk_bf16_f32 v155, v118, v119
    v_exp_f32 v121, v121
    v_exp_f32 v122, v122
    s_waitcnt lgkmcnt(10)
    v_mfma_f32_32x32x16_bf16 v[192:207], a[40:43], v[152:155], v[192:207]
    v_exp_f32 v123, v123
    v_cvt_pk_bf16_f32 v156, v120, v121
    v_exp_f32 v124, v124
    v_exp_f32 v125, v125
    v_cvt_pk_bf16_f32 v157, v122, v123
    ds_read_b128 a[24:27], v162 offset:6144
    ds_read_b128 a[80:83], v163 offset:6240
    ds_read_b128 a[84:87], v164 offset:6240
    v_exp_f32 v126, v126
    v_exp_f32 v127, v127
    v_cvt_pk_bf16_f32 v158, v124, v125
    v_cvt_pk_bf16_f32 v159, v126, v127
    buffer_load_dword v140, v169, s[32:35], 0 offen sc1
    v_mfma_f32_32x32x16_bf16 v[112:127], a[4:7], v[52:55], 0
    v_exp_f32 v96, v96
    v_exp_f32 v97, v97
    v_exp_f32 v98, v98
    s_waitcnt lgkmcnt(12)
    v_mfma_f32_32x32x16_bf16 v[192:207], a[44:47], v[156:159], v[192:207]
    v_exp_f32 v99, v99
    v_cvt_pk_bf16_f32 v144, v96, v97
    v_exp_f32 v100, v100
    v_cvt_pk_bf16_f32 v145, v98, v99
    v_exp_f32 v101, v101
    v_exp_f32 v102, v102
    v_cvt_pk_bf16_f32 v146, v100, v101
    v_mov_b32 v24, -1
    v_mov_b32 v25, -1
    v_mov_b32 v26, -1
    v_exp_f32 v103, v103
    v_exp_f32 v104, v104
    v_cvt_pk_bf16_f32 v147, v102, v103
    v_exp_f32 v105, v105
    v_exp_f32 v106, v106
    v_mfma_f32_32x32x16_bf16 v[208:223], a[32:35], v[144:147], 0
    v_exp_f32 v107, v107
    v_cvt_pk_bf16_f32 v148, v104, v105
    v_exp_f32 v108, v108
    v_exp_f32 v109, v109
    v_cvt_pk_bf16_f32 v149, v106, v107
    v_mov_b32 v27, -1
    v_exp_f32 v110, v110
    v_exp_f32 v111, v111
    v_cvt_pk_bf16_f32 v150, v108, v109
    v_cvt_pk_bf16_f32 v151, v110, v111
    s_waitcnt lgkmcnt(11)
    v_mfma_f32_32x32x16_bf16 v[96:111], a[8:11], v[52:55], v[64:79]
    v_exp_f32 v112, v112
    v_exp_f32 v113, v113
    v_exp_f32 v114, v114
    v_mfma_f32_32x32x16_bf16 v[208:223], a[36:39], v[148:151], v[208:223]
    v_exp_f32 v115, v115
    v_cvt_pk_bf16_f32 v152, v112, v113
    v_exp_f32 v116, v116
    v_cvt_pk_bf16_f32 v153, v114, v115
    v_exp_f32 v117, v117
    v_exp_f32 v118, v118
    v_cvt_pk_bf16_f32 v154, v116, v117
    v_exp_f32 v119, v119
    v_exp_f32 v120, v120
    v_cvt_pk_bf16_f32 v155, v118, v119
    v_exp_f32 v121, v121
    v_exp_f32 v122, v122
    v_mfma_f32_32x32x16_bf16 v[208:223], a[40:43], v[152:155], v[208:223]
    v_exp_f32 v123, v123
    v_cvt_pk_bf16_f32 v156, v120, v121
    v_exp_f32 v124, v124
    v_exp_f32 v125, v125
    v_cvt_pk_bf16_f32 v157, v122, v123
    v_exp_f32 v126, v126
    v_exp_f32 v127, v127
    v_cvt_pk_bf16_f32 v158, v124, v125
    v_cvt_pk_bf16_f32 v159, v126, v127
    s_waitcnt lgkmcnt(0)
    s_barrier
    v_and_b32 v141, v170, v30
    s_waitcnt vmcnt(0)
    v_cmp_ne_u32 vcc, v140, v141
    s_nop 1
    s_cbranch_vccz L_polld_15
    s_mov_b32 s95, 131072
L_poll_14:
    buffer_load_dword v140, v169, s[32:35], 0 offen sc1
    s_waitcnt vmcnt(0)
    v_cmp_ne_u32 vcc, v140, v141
    s_nop 1
    s_cbranch_vccz L_polld_15
    s_sub_u32 s95, s95, 1
    s_cmp_lg_u32 s95, 0
    s_cbranch_scc1 L_poll_14
L_polld_15:
    v_mfma_f32_32x32x16_bf16 v[112:127], a[16:19], v[56:59], 0
    v_exp_f32 v96, v96
    v_exp_f32 v97, v97
    v_exp_f32 v98, v98
    v_mfma_f32_32x32x16_bf16 v[208:223], a[44:47], v[156:159], v[208:223]
    v_exp_f32 v99, v99
    v_cvt_pk_bf16_f32 v144, v96, v97
    v_exp_f32 v100, v100
    v_cvt_pk_bf16_f32 v145, v98, v99
    v_exp_f32 v101, v101
    v_exp_f32 v102, v102
    v_cvt_pk_bf16_f32 v146, v100, v101
    s_lshl_b32 s76, s2, 2
    s_add_u32 s76, s76, s68
    s_and_b32 s77, s76, 511
    buffer_load_dwordx4 a[100:103], v1, s[40:43], s12 offen offset:1024 sc1
    buffer_load_dwordx4 a[136:139], v160, s[40:43], s14 offen offset:1152 sc1
    v_exp_f32 v103, v103
    v_exp_f32 v104, v104
    v_cvt_pk_bf16_f32 v147, v102, v103
    v_exp_f32 v105, v105
    v_exp_f32 v106, v106
    v_mfma_f32_32x32x16_bf16 v[208:223], a[48:51], v[144:147], v[208:223]
    v_exp_f32 v107, v107
    v_cvt_pk_bf16_f32 v148, v104, v105
    v_exp_f32 v108, v108
    v_exp_f32 v109, v109
    v_cvt_pk_bf16_f32 v149, v106, v107
    s_lshl_b32 s77, s77, 10
    s_cmp_lt_u32 s76, 512
    s_cselect_b32 s92, s44, s48
    s_cselect_b32 s93, s45, s49
    s_add_u32 s92, s92, s77
    s_addc_u32 s93, s93, 0
    buffer_load_dwordx4 a[140:143], v161, s[40:43], s14 offen offset:1152 sc1
    v_exp_f32 v110, v110
    v_exp_f32 v111, v111
    v_cvt_pk_bf16_f32 v150, v108, v109
    v_cvt_pk_bf16_f32 v151, v110, v111
    v_mfma_f32_32x32x16_bf16 v[96:111], a[20:23], v[56:59], v[64:79]
    v_exp_f32 v112, v112
    v_exp_f32 v113, v113
    v_exp_f32 v114, v114
    v_mfma_f32_32x32x16_bf16 v[208:223], a[52:55], v[148:151], v[208:223]
    v_exp_f32 v115, v115
    v_cvt_pk_bf16_f32 v152, v112, v113
    v_exp_f32 v116, v116
    v_cvt_pk_bf16_f32 v153, v114, v115
    v_exp_f32 v117, v117
    v_exp_f32 v118, v118
    v_cvt_pk_bf16_f32 v154, v116, v117
    s_load_dword s75, s[92:93], 0
    s_load_dword s75, s[92:93], 64
    s_load_dword s75, s[92:93], 128
    buffer_load_dwordx4 a[104:107], v1, s[40:43], s12 offen offset:2048 sc1
    buffer_load_dwordx4 a[144:147], v160, s[40:43], s14 offen offset:2304 sc1
    v_exp_f32 v119, v119
    v_exp_f32 v120, v120
    v_cvt_pk_bf16_f32 v155, v118, v119
    v_exp_f32 v121, v121
    v_exp_f32 v122, v122
    v_mfma_f32_32x32x16_bf16 v[224:239], a[64:67], v[152:155], 0
    v_exp_f32 v123, v123
    v_cvt_pk_bf16_f32 v156, v120, v121
    v_exp_f32 v124, v124
    v_exp_f32 v125, v125
    v_cvt_pk_bf16_f32 v157, v122, v123
    s_load_dword s75, s[92:93], 192
    s_load_dword s75, s[92:93], 256
    s_load_dword s75, s[92:93], 320
    buffer_load_dwordx4 a[148:151], v161, s[40:43], s14 offen offset:2304 sc1
    v_exp_f32 v126, v126
    v_exp_f32 v127, v127
    v_cvt_pk_bf16_f32 v158, v124, v125
    v_cvt_pk_bf16_f32 v159, v126, v127
    v_mfma_f32_32x32x16_bf16 v[112:127], a[16:19], v[60:63], 0
    v_exp_f32 v96, v96
    v_exp_f32 v97, v97
    v_exp_f32 v98, v98
    v_mfma_f32_32x32x16_bf16 v[224:239], a[68:71], v[156:159], v[224:239]
    v_exp_f32 v99, v99
    v_cvt_pk_bf16_f32 v144, v96, v97
    v_exp_f32 v100, v100
    v_cvt_pk_bf16_f32 v145, v98, v99
    v_exp_f32 v101, v101
    v_exp_f32 v102, v102
    v_cvt_pk_bf16_f32 v146, v100, v101
    s_load_dword s75, s[92:93], 384
    s_load_dword s75, s[92:93], 448
    s_load_dword s75, s[92:93], 512
    buffer_load_dwordx4 a[108:111], v1, s[40:43], s12 offen offset:3072 sc1
    buffer_load_dwordx4 a[152:155], v160, s[40:43], s14 offen offset:3456 sc1
    v_exp_f32 v103, v103
    v_exp_f32 v104, v104
    v_cvt_pk_bf16_f32 v147, v102, v103
    v_exp_f32 v105, v105
    v_exp_f32 v106, v106
    v_mfma_f32_32x32x16_bf16 v[224:239], a[72:75], v[144:147], v[224:239]
    v_exp_f32 v107, v107
    v_cvt_pk_bf16_f32 v148, v104, v105
    v_exp_f32 v108, v108
    v_exp_f32 v109, v109
    v_cvt_pk_bf16_f32 v149, v106, v107
    s_load_dword s75, s[92:93], 576
    s_load_dword s75, s[92:93], 640
    s_load_dword s75, s[92:93], 704
    buffer_load_dwordx4 a[156:159], v161, s[40:43], s14 offen offset:3456 sc1
    v_exp_f32 v110, v110
    v_exp_f32 v111, v111
    v_cvt_pk_bf16_f32 v150, v108, v109
    v_cvt_pk_bf16_f32 v151, v110, v111
    v_mfma_f32_32x32x16_bf16 v[96:111], a[20:23], v[60:63], 0
    v_exp_f32 v112, v112
    v_exp_f32 v113, v113
    v_exp_f32 v114, v114
    v_mfma_f32_32x32x16_bf16 v[224:239], a[76:79], v[148:151], v[224:239]
    v_exp_f32 v115, v115
    v_cvt_pk_bf16_f32 v152, v112, v113
    v_exp_f32 v116, v116
    v_cvt_pk_bf16_f32 v153, v114, v115
    v_exp_f32 v117, v117
    v_exp_f32 v118, v118
    v_cvt_pk_bf16_f32 v154, v116, v117
    s_load_dword s75, s[92:93], 768
    s_load_dword s75, s[92:93], 832
    s_load_dword s75, s[92:93], 896
    buffer_load_dwordx4 a[112:115], v1, s[36:39], s13 offen offset:0 sc1
    buffer_load_dwordx4 a[160:163], v160, s[36:39], s15 offen offset:0 sc1
    v_exp_f32 v119, v119
    v_exp_f32 v120, v120
    v_cvt_pk_bf16_f32 v155, v118, v119
    v_exp_f32 v121, v121
    v_exp_f32 v122, v122
    v_mfma_f32_32x32x16_bf16 v[240:255], a[64:67], v[152:155], 0
    v_exp_f32 v123, v123
    v_cvt_pk_bf16_f32 v156, v120, v121
    v_exp_f32 v124, v124
    v_exp_f32 v125, v125
    v_cvt_pk_bf16_f32 v157, v122, v123
    s_load_dword s75, s[92:93], 960
    s_lshr_b32 s76, s2, 3
    s_lshl_b32 s76, s76, 2
    buffer_load_dwordx4 a[164:167], v161, s[36:39], s15 offen offset:0 sc1
    v_exp_f32 v126, v126
    v_exp_f32 v127, v127
    v_cvt_pk_bf16_f32 v158, v124, v125
    v_cvt_pk_bf16_f32 v159, v126, v127
    v_mfma_f32_32x32x16_bf16 v[112:127], a[24:27], v[60:63], v[64:79]
    v_exp_f32 v96, v96
    v_exp_f32 v97, v97
    v_exp_f32 v98, v98
    v_mfma_f32_32x32x16_bf16 v[240:255], a[68:71], v[156:159], v[240:255]
    v_exp_f32 v99, v99
    v_cvt_pk_bf16_f32 v144, v96, v97
    v_exp_f32 v100, v100
    v_cvt_pk_bf16_f32 v145, v98, v99
    v_exp_f32 v101, v101
    v_exp_f32 v102, v102
    v_cvt_pk_bf16_f32 v146, v100, v101
    s_add_u32 s76, s76, s68
    s_and_b32 s77, s76, 63
    s_lshl_b32 s77, s77, 13
    buffer_load_dwordx4 a[116:119], v1, s[36:39], s13 offen offset:1024 sc1
    buffer_load_dwordx4 a[168:171], v160, s[36:39], s15 offen offset:1152 sc1
    v_exp_f32 v103, v103
    v_exp_f32 v104, v104
    v_cvt_pk_bf16_f32 v147, v102, v103
    v_exp_f32 v105, v105
    v_exp_f32 v106, v106
    v_mfma_f32_32x32x16_bf16 v[240:255], a[72:75], v[144:147], v[240:255]
    v_exp_f32 v107, v107
    v_cvt_pk_bf16_f32 v148, v104, v105
    v_exp_f32 v108, v108
    v_exp_f32 v109, v109
    v_cvt_pk_bf16_f32 v149, v106, v107
    s_cmp_lt_u32 s76, 64
    s_cselect_b32 s92, s44, s48
    s_cselect_b32 s93, s45, s49
    s_add_u32 s92, s92, s77
    s_addc_u32 s93, s93, 0
    s_load_dword s75, s[92:93], 384
    buffer_load_dwordx4 a[172:175], v161, s[36:39], s15 offen offset:1152 sc1
    v_exp_f32 v110, v110
    v_exp_f32 v111, v111
    v_cvt_pk_bf16_f32 v150, v108, v109
    v_cvt_pk_bf16_f32 v151, v110, v111
    s_waitcnt vmcnt(12)
    v_mfma_f32_32x32x16_bf16 v[96:111], a[100:103], v[48:51], v[80:95]
    v_exp_f32 v112, v112
    v_exp_f32 v113, v113
    v_exp_f32 v114, v114
    v_mfma_f32_32x32x16_bf16 v[240:255], a[76:79], v[148:151], v[240:255]
    v_exp_f32 v115, v115
    v_cvt_pk_bf16_f32 v152, v112, v113
    v_exp_f32 v116, v116
    v_cvt_pk_bf16_f32 v153, v114, v115
    v_exp_f32 v117, v117
    v_exp_f32 v118, v118
    v_cvt_pk_bf16_f32 v154, v116, v117
    s_load_dword s75, s[92:93], 448
    s_load_dword s75, s[92:93], 1408
    s_load_dword s75, s[92:93], 1472
    buffer_load_dwordx4 a[120:123], v1, s[36:39], s13 offen offset:2048 sc1
L_stub_5:
    s_cbranch_execz L_warm_back
    buffer_load_dwordx4 a[176:179], v160, s[36:39], s15 offen offset:2304 sc1
    v_exp_f32 v119, v119
    v_exp_f32 v120, v120
    v_cvt_pk_bf16_f32 v155, v118, v119
    v_exp_f32 v121, v121
    v_exp_f32 v122, v122
    v_mfma_f32_32x32x16_bf16 v[240:255], a[80:83], v[152:155], v[240:255]
    v_exp_f32 v123, v123
    v_cvt_pk_bf16_f32 v156, v120, v121
    v_exp_f32 v124, v124
    v_exp_f32 v125, v125
    v_cvt_pk_bf16_f32 v157, v122, v123
    s_load_dword s75, s[92:93], 2432
    s_load_dword s75, s[92:93], 2496
    s_load_dword s75, s[92:93], 3456
    buffer_load_dwordx4 a[180:183], v161, s[36:39], s15 offen offset:2304 sc1
    v_exp_f32 v126, v126
    v_exp_f32 v127, v127
    v_cvt_pk_bf16_f32 v158, v124, v125
    v_cvt_pk_bf16_f32 v159, v126, v127
    s_waitcnt vmcnt(12)
    v_mfma_f32_32x32x16_bf16 v[112:127], a[104:107], v[48:51], 0
    v_exp_f32 v96, v96
    v_exp_f32 v97, v97
    v_exp_f32 v98, v98
    v_mfma_f32_32x32x16_bf16 v[240:255], a[84:87], v[156:159], v[240:255]
    v_exp_f32 v99, v99
    v_cvt_pk_bf16_f32 v144, v96, v97
    v_exp_f32 v100, v100
    v_cvt_pk_bf16_f32 v145, v98, v99
    v_exp_f32 v101, v101
    v_exp_f32 v102, v102
    v_cvt_pk_bf16_f32 v146, v100, v101
    s_load_dword s75, s[92:93], 3520
    s_load_dword s75, s[92:93], 4480
    s_load_dword s75, s[92:93], 4544
    buffer_load_dwordx4 a[124:127], v1, s[36:39], s13 offen offset:3072 sc1
    buffer_load_dwordx4 a[184:187], v160, s[36:39], s15 offen offset:3456 sc1
    v_exp_f32 v103, v103
    v_exp_f32 v104, v104
    v_cvt_pk_bf16_f32 v147, v102, v103
    v_exp_f32 v105, v105
    v_exp_f32 v106, v106
    v_mfma_f32_32x32x16_bf16 v[192:207], a[136:139], v[144:147], v[192:207]
    v_exp_f32 v107, v107
    v_cvt_pk_bf16_f32 v148, v104, v105
    v_exp_f32 v108, v108
    v_exp_f32 v109, v109
    v_cvt_pk_bf16_f32 v149, v106, v107
    s_load_dword s75, s[92:93], 5504
    s_load_dword s75, s[92:93], 5568
    s_load_dword s75, s[92:93], 6528
    buffer_load_dwordx4 a[188:191], v161, s[36:39], s15 offen offset:3456 sc1
    v_exp_f32 v110, v110
    v_exp_f32 v111, v111
    v_cvt_pk_bf16_f32 v150, v108, v109
    v_cvt_pk_bf16_f32 v151, v110, v111
    v_mfma_f32_32x32x16_bf16 v[96:111], a[104:107], v[52:55], v[80:95]
    v_exp_f32 v112, v112
    v_exp_f32 v113, v113
    v_exp_f32 v114, v114
    v_mfma_f32_32x32x16_bf16 v[192:207], a[140:143], v[148:151], v[192:207]
    v_exp_f32 v115, v115
    v_cvt_pk_bf16_f32 v152, v112, v113
    v_exp_f32 v116, v116
    v_cvt_pk_bf16_f32 v153, v114, v115
    v_exp_f32 v117, v117
    v_exp_f32 v118, v118
    v_cvt_pk_bf16_f32 v154, v116, v117
    s_load_dword s75, s[92:93], 6592
    s_load_dword s75, s[92:93], 7552
    s_load_dword s75, s[92:93], 7616
    buffer_load_dwordx4 a[4:7], v1, s[40:43], s20 offen offset:1024 sc1
    buffer_load_dwordx4 a[40:43], v160, s[40:43], s22 offen offset:1152 sc1
    v_exp_f32 v119, v119
    v_exp_f32 v120, v120
    v_cvt_pk_bf16_f32 v155, v118, v119
    v_exp_f32 v121, v121
    v_exp_f32 v122, v122
    v_mfma_f32_32x32x16_bf16 v[192:207], a[144:147], v[152:155], v[192:207]
    v_exp_f32 v123, v123
    v_cvt_pk_bf16_f32 v156, v120, v121
    v_exp_f32 v124, v124
    v_exp_f32 v125, v125
    v_cvt_pk_bf16_f32 v157, v122, v123
    buffer_load_dwordx4 a[44:47], v161, s[40:43], s22 offen offset:1152 sc1
    v_exp_f32 v126, v126
    v_exp_f32 v127, v127
    v_cvt_pk_bf16_f32 v158, v124, v125
    v_cvt_pk_bf16_f32 v159, v126, v127
    s_waitcnt vmcnt(15)
    v_mfma_f32_32x32x16_bf16 v[112:127], a[108:111], v[48:51], 0
    v_exp_f32 v96, v96
    v_exp_f32 v97, v97
    v_exp_f32 v98, v98
    v_mfma_f32_32x32x16_bf16 v[192:207], a[148:151], v[156:159], v[192:207]
    v_exp_f32 v99, v99
    v_cvt_pk_bf16_f32 v144, v96, v97
    v_exp_f32 v100, v100
    v_cvt_pk_bf16_f32 v145, v98, v99
    v_exp_f32 v101, v101
    v_exp_f32 v102, v102
    v_cvt_pk_bf16_f32 v146, v100, v101
    buffer_load_dwordx4 a[8:11], v1, s[40:43], s20 offen offset:2048 sc1
    buffer_load_dwordx4 a[48:51], v160, s[40:43], s22 offen offset:2304 sc1
    v_exp_f32 v103, v103
    v_exp_f32 v104, v104
    v_cvt_pk_bf16_f32 v147, v102, v103
    v_exp_f32 v105, v105
    v_exp_f32 v106, v106
    v_mfma_f32_32x32x16_bf16 v[208:223], a[144:147], v[144:147], v[208:223]
    v_exp_f32 v107, v107
    v_cvt_pk_bf16_f32 v148, v104, v105
    v_exp_f32 v108, v108
    v_exp_f32 v109, v109
    v_cvt_pk_bf16_f32 v149, v106, v107
    buffer_load_dwordx4 a[52:55], v161, s[40:43], s22 offen offset:2304 sc1
    v_exp_f32 v110, v110
    v_exp_f32 v111, v111
    v_cvt_pk_bf16_f32 v150, v108, v109
    v_cvt_pk_bf16_f32 v151, v110, v111
    v_mfma_f32_32x32x16_bf16 v[96:111], a[108:111], v[52:55], 0
    v_exp_f32 v112, v112
    v_exp_f32 v113, v113
    v_exp_f32 v114, v114
    v_mfma_f32_32x32x16_bf16 v[208:223], a[148:151], v[148:151], v[208:223]
    v_exp_f32 v115, v115
    v_cvt_pk_bf16_f32 v152, v112, v113
    v_exp_f32 v116, v116
    v_cvt_pk_bf16_f32 v153, v114, v115
    v_exp_f32 v117, v117
    v_exp_f32 v118, v118
    v_cvt_pk_bf16_f32 v154, v116, v117
    buffer_load_dwordx4 a[12:15], v1, s[40:43], s20 offen offset:3072 sc1
    buffer_load_dwordx4 a[56:59], v160, s[40:43], s22 offen offset:3456 sc1
    v_exp_f32 v119, v119
    v_exp_f32 v120, v120
    v_cvt_pk_bf16_f32 v155, v118, v119
    v_exp_f32 v121, v121
    v_exp_f32 v122, v122
    v_mfma_f32_32x32x16_bf16 v[192:207], a[152:155], v[152:155], v[192:207]
    v_exp_f32 v123, v123
    v_cvt_pk_bf16_f32 v156, v120, v121
    v_exp_f32 v124, v124
    v_exp_f32 v125, v125
    v_cvt_pk_bf16_f32 v157, v122, v123
    buffer_load_dwordx4 a[60:63], v161, s[40:43], s22 offen offset:3456 sc1
    v_exp_f32 v126, v126
    v_exp_f32 v127, v127
    v_cvt_pk_bf16_f32 v158, v124, v125
    v_cvt_pk_bf16_f32 v159, v126, v127
    s_waitcnt vmcnt(18)
    v_mfma_f32_32x32x16_bf16 v[112:127], a[112:115], v[48:51], 0
    v_exp_f32 v96, v96
    v_exp_f32 v97, v97
    v_exp_f32 v98, v98
    v_mfma_f32_32x32x16_bf16 v[192:207], a[156:159], v[156:159], v[192:207]
    v_exp_f32 v99, v99
    v_cvt_pk_bf16_f32 v144, v96, v97
    v_exp_f32 v100, v100
    v_cvt_pk_bf16_f32 v145, v98, v99
    v_exp_f32 v101, v101
    v_exp_f32 v102, v102
    v_cvt_pk_bf16_f32 v146, v100, v101
    buffer_load_dwordx4 a[16:19], v1, s[36:39], s21 offen offset:0 sc1
    buffer_load_dwordx4 a[64:67], v160, s[36:39], s23 offen offset:0 sc1
    v_exp_f32 v103, v103
    v_exp_f32 v104, v104
    v_cvt_pk_bf16_f32 v147, v102, v103
    v_exp_f32 v105, v105
    v_exp_f32 v106, v106
    v_mfma_f32_32x32x16_bf16 v[208:223], a[152:155], v[144:147], v[208:223]
    v_exp_f32 v107, v107
    v_cvt_pk_bf16_f32 v148, v104, v105
    v_exp_f32 v108, v108
    v_exp_f32 v109, v109
    v_cvt_pk_bf16_f32 v149, v106, v107
    buffer_load_dwordx4 a[68:71], v161, s[36:39], s23 offen offset:0 sc1
    v_exp_f32 v110, v110
    v_exp_f32 v111, v111
    v_cvt_pk_bf16_f32 v150, v108, v109
    v_cvt_pk_bf16_f32 v151, v110, v111
    v_mfma_f32_32x32x16_bf16 v[96:111], a[112:115], v[52:55], 0
    v_exp_f32 v112, v112
    v_exp_f32 v113, v113
    v_exp_f32 v114, v114
    v_mfma_f32_32x32x16_bf16 v[208:223], a[156:159], v[148:151], v[208:223]
    v_exp_f32 v115, v115
    v_cvt_pk_bf16_f32 v152, v112, v113
    v_exp_f32 v116, v116
    v_cvt_pk_bf16_f32 v153, v114, v115
    v_exp_f32 v117, v117
    v_exp_f32 v118, v118
    v_cvt_pk_bf16_f32 v154, v116, v117
    buffer_load_dwordx4 a[20:23], v1, s[36:39], s21 offen offset:1024 sc1
    buffer_load_dwordx4 a[72:75], v160, s[36:39], s23 offen offset:1152 sc1
    v_exp_f32 v119, v119
    v_exp_f32 v120, v120
    v_cvt_pk_bf16_f32 v155, v118, v119
    v_exp_f32 v121, v121
    v_exp_f32 v122, v122
    v_mfma_f32_32x32x16_bf16 v[192:207], a[160:163], v[152:155], v[192:207]
    v_exp_f32 v123, v123
    v_cvt_pk_bf16_f32 v156, v120, v121
    v_exp_f32 v124, v124
    v_exp_f32 v125, v125
    v_cvt_pk_bf16_f32 v157, v122, v123
    buffer_load_dwordx4 a[76:79], v161, s[36:39], s23 offen offset:1152 sc1
    v_exp_f32 v126, v126
    v_exp_f32 v127, v127
    v_cvt_pk_bf16_f32 v158, v124, v125
    v_cvt_pk_bf16_f32 v159, v126, v127
    s_waitcnt vmcnt(21)
    v_mfma_f32_32x32x16_bf16 v[112:127], a[116:119], v[48:51], 0
    v_exp_f32 v96, v96
    v_exp_f32 v97, v97
    v_exp_f32 v98, v98
    v_mfma_f32_32x32x16_bf16 v[192:207], a[164:167], v[156:159], v[192:207]
    v_exp_f32 v99, v99
    v_cvt_pk_bf16_f32 v144, v96, v97
    v_exp_f32 v100, v100
    v_cvt_pk_bf16_f32 v145, v98, v99
    v_exp_f32 v101, v101
    v_exp_f32 v102, v102
    v_cvt_pk_bf16_f32 v146, v100, v101
    buffer_load_dwordx4 a[24:27], v1, s[36:39], s21 offen offset:2048 sc1
    buffer_load_dwordx4 a[80:83], v160, s[36:39], s23 offen offset:2304 sc1
    v_exp_f32 v103, v103
    v_exp_f32 v104, v104
    v_cvt_pk_bf16_f32 v147, v102, v103
    v_exp_f32 v105, v105
    v_exp_f32 v106, v106
    v_mfma_f32_32x32x16_bf16 v[208:223], a[160:163], v[144:147], v[208:223]
    v_exp_f32 v107, v107
    v_cvt_pk_bf16_f32 v148, v104, v105
    v_exp_f32 v108, v108
    v_exp_f32 v109, v109
    v_cvt_pk_bf16_f32 v149, v106, v107
    buffer_load_dwordx4 a[84:87], v161, s[36:39], s23 offen offset:2304 sc1
    v_exp_f32 v110, v110
    v_exp_f32 v111, v111
    v_cvt_pk_bf16_f32 v150, v108, v109
    v_cvt_pk_bf16_f32 v151, v110, v111
    v_mfma_f32_32x32x16_bf16 v[96:111], a[116:119], v[52:55], 0
    v_exp_f32 v112, v112
    v_exp_f32 v113, v113
    v_exp_f32 v114, v114
    v_mfma_f32_32x32x16_bf16 v[208:223], a[164:167], v[148:151], v[208:223]
    v_exp_f32 v115, v115
    v_cvt_pk_bf16_f32 v152, v112, v113
    v_exp_f32 v116, v116
    v_cvt_pk_bf16_f32 v153, v114, v115
    v_exp_f32 v117, v117
    v_exp_f32 v118, v118
    v_cvt_pk_bf16_f32 v154, v116, v117
    buffer_load_dwordx4 a[28:31], v1, s[36:39], s21 offen offset:3072 sc1
    buffer_load_dwordx4 a[88:91], v160, s[36:39], s23 offen offset:3456 sc1
    v_exp_f32 v119, v119
    v_exp_f32 v120, v120
    v_cvt_pk_bf16_f32 v155, v118, v119
    v_exp_f32 v121, v121
    v_exp_f32 v122, v122
    v_mfma_f32_32x32x16_bf16 v[192:207], a[168:171], v[152:155], v[192:207]
    v_exp_f32 v123, v123
    v_cvt_pk_bf16_f32 v156, v120, v121
    v_exp_f32 v124, v124
    v_exp_f32 v125, v125
    v_cvt_pk_bf16_f32 v157, v122, v123
    buffer_load_dwordx4 a[92:95], v161, s[36:39], s23 offen offset:3456 sc1
    v_exp_f32 v126, v126
    v_exp_f32 v127, v127
    v_cvt_pk_bf16_f32 v158, v124, v125
    v_cvt_pk_bf16_f32 v159, v126, v127
    s_waitcnt vmcnt(24)
    v_mfma_f32_32x32x16_bf16 v[112:127], a[120:123], v[48:51], 0
    v_exp_f32 v96, v96
    v_exp_f32 v97, v97
    v_exp_f32 v98, v98
    v_mfma_f32_32x32x16_bf16 v[192:207], a[172:175], v[156:159], v[192:207]
    v_exp_f32 v99, v99
    v_cvt_pk_bf16_f32 v144, v96, v97
    v_exp_f32 v100, v100
    v_cvt_pk_bf16_f32 v145, v98, v99
    v_exp_f32 v101, v101
    v_exp_f32 v102, v102
    v_cvt_pk_bf16_f32 v146, v100, v101
    buffer_store_dwordx4 v[24:27], v1, s[32:35], s18 offen sc1
    buffer_store_dwordx4 v[24:27], v1, s[32:35], s19 offen sc1
    s_add_u32 m0, s71, 0x8000
    v_exp_f32 v103, v103
    v_exp_f32 v104, v104
    v_cvt_pk_bf16_f32 v147, v102, v103
    v_exp_f32 v105, v105
    v_exp_f32 v106, v106
    v_mfma_f32_32x32x16_bf16 v[208:223], a[168:171], v[144:147], v[208:223]
    v_exp_f32 v107, v107
    v_cvt_pk_bf16_f32 v148, v104, v105
    v_exp_f32 v108, v108
    v_exp_f32 v109, v109
    v_cvt_pk_bf16_f32 v149, v106, v107
    buffer_load_dwordx4 v172, s[44:47], s11 offen offset:0 lds
    v_exp_f32 v110, v110
    v_exp_f32 v111, v111
    v_cvt_pk_bf16_f32 v150, v108, v109
    v_cvt_pk_bf16_f32 v151, v110, v111
    v_mfma_f32_32x32x16_bf16 v[96:111], a[120:123], v[52:55], 0
    v_exp_f32 v112, v112
    v_exp_f32 v113, v113
    v_exp_f32 v114, v114
    v_mfma_f32_32x32x16_bf16 v[208:223], a[172:175], v[148:151], v[208:223]
    v_exp_f32 v115, v115
    v_cvt_pk_bf16_f32 v152, v112, v113
    v_exp_f32 v116, v116
    v_cvt_pk_bf16_f32 v153, v114, v115
    v_exp_f32 v117, v117
    v_exp_f32 v118, v118
    v_cvt_pk_bf16_f32 v154, v116, v117
    buffer_load_dwordx4 v173, s[44:47], s11 offen offset:1024 lds
    buffer_load_dwordx4 v174, s[44:47], s11 offen offset:2048 lds
    v_exp_f32 v119, v119
    v_exp_f32 v120, v120
    v_cvt_pk_bf16_f32 v155, v118, v119
    v_exp_f32 v121, v121
    v_exp_f32 v122, v122
    v_mfma_f32_32x32x16_bf16 v[192:207], a[176:179], v[152:155], v[192:207]
    v_exp_f32 v123, v123
    v_cvt_pk_bf16_f32 v156, v120, v121
    v_exp_f32 v124, v124
    v_exp_f32 v125, v125
    v_cvt_pk_bf16_f32 v157, v122, v123
    buffer_load_dwordx4 v175, s[44:47], s11 offen offset:3072 lds
    s_add_u32 m0, s71, 0x18000
    v_exp_f32 v126, v126
    v_exp_f32 v127, v127
    v_cvt_pk_bf16_f32 v158, v124, v125
    v_cvt_pk_bf16_f32 v159, v126, v127
    s_waitcnt vmcnt(27)
    v_mfma_f32_32x32x16_bf16 v[112:127], a[124:127], v[48:51], 0
    v_exp_f32 v96, v96
    v_exp_f32 v97, v97
    v_exp_f32 v98, v98
    v_mfma_f32_32x32x16_bf16 v[192:207], a[180:183], v[156:159], v[192:207]
    v_exp_f32 v99, v99
    v_cvt_pk_bf16_f32 v144, v96, v97
    v_exp_f32 v100, v100
    v_cvt_pk_bf16_f32 v145, v98, v99
    v_exp_f32 v101, v101
    v_exp_f32 v102, v102
    v_cvt_pk_bf16_f32 v146, v100, v101
    buffer_load_dwordx4 v172, s[48:51], s11 offen offset:0 lds
    buffer_load_dwordx4 v173, s[48:51], s11 offen offset:1024 lds
    v_exp_f32 v103, v103
    v_exp_f32 v104, v104
    v_cvt_pk_bf16_f32 v147, v102, v103
    v_exp_f32 v105, v105
    v_exp_f32 v106, v106
    v_mfma_f32_32x32x16_bf16 v[208:223], a[176:179], v[144:147], v[208:223]
    v_exp_f32 v107, v107
    v_cvt_pk_bf16_f32 v148, v104, v105
    v_exp_f32 v108, v108
    v_exp_f32 v109, v109
    v_cvt_pk_bf16_f32 v149, v106, v107
    buffer_load_dwordx4 v174, s[48:51], s11 offen offset:2048 lds
    v_exp_f32 v110, v110
    v_exp_f32 v111, v111
    v_cvt_pk_bf16_f32 v150, v108, v109
    v_cvt_pk_bf16_f32 v151, v110, v111
    v_mfma_f32_32x32x16_bf16 v[96:111], a[124:127], v[52:55], 0
    v_exp_f32 v112, v112
    v_exp_f32 v113, v113
    v_exp_f32 v114, v114
    v_mfma_f32_32x32x16_bf16 v[208:223], a[180:183], v[148:151], v[208:223]
    v_exp_f32 v115, v115
    v_cvt_pk_bf16_f32 v152, v112, v113
    v_exp_f32 v116, v116
    v_cvt_pk_bf16_f32 v153, v114, v115
    v_exp_f32 v117, v117
    v_exp_f32 v118, v118
    v_cvt_pk_bf16_f32 v154, v116, v117
    buffer_load_dwordx4 v175, s[48:51], s11 offen offset:3072 lds
    s_add_u32 s85, s11, 131072
    s_add_u32 m0, s71, 0x1c000
    v_exp_f32 v119, v119
    v_exp_f32 v120, v120
    v_cvt_pk_bf16_f32 v155, v118, v119
    v_exp_f32 v121, v121
    v_exp_f32 v122, v122
    v_mfma_f32_32x32x16_bf16 v[192:207], a[184:187], v[152:155], v[192:207]
    v_exp_f32 v123, v123
    v_cvt_pk_bf16_f32 v156, v120, v121
    v_exp_f32 v124, v124
    v_exp_f32 v125, v125
    v_cvt_pk_bf16_f32 v157, v122, v123
    buffer_load_dwordx4 v172, s[48:51], s85 offen offset:0 lds
    v_exp_f32 v126, v126
    v_exp_f32 v127, v127
    v_cvt_pk_bf16_f32 v158, v124, v125
    v_cvt_pk_bf16_f32 v159, v126, v127
    s_waitcnt vmcnt(29)
    v_mfma_f32_32x32x16_bf16 v[112:127], a[4:7], v[56:59], v[80:95]
    v_exp_f32 v96, v96
    v_exp_f32 v97, v97
    v_exp_f32 v98, v98
    v_mfma_f32_32x32x16_bf16 v[192:207], a[188:191], v[156:159], v[192:207]
    v_exp_f32 v99, v99
    v_cvt_pk_bf16_f32 v144, v96, v97
    v_exp_f32 v100, v100
    v_cvt_pk_bf16_f32 v145, v98, v99
    v_exp_f32 v101, v101
    v_exp_f32 v102, v102
    v_cvt_pk_bf16_f32 v146, v100, v101
    buffer_load_dwordx4 v173, s[48:51], s85 offen offset:1024 lds
    buffer_load_dwordx4 v174, s[48:51], s85 offen offset:2048 lds
    v_exp_f32 v103, v103
    v_exp_f32 v104, v104
    v_cvt_pk_bf16_f32 v147, v102, v103
    v_exp_f32 v105, v105
    v_exp_f32 v106, v106
    v_mfma_f32_32x32x16_bf16 v[208:223], a[184:187], v[144:147], v[208:223]
    v_exp_f32 v107, v107
    v_cvt_pk_bf16_f32 v148, v104, v105
    v_exp_f32 v108, v108
    v_exp_f32 v109, v109
    v_cvt_pk_bf16_f32 v149, v106, v107
    buffer_load_dwordx4 v175, s[48:51], s85 offen offset:3072 lds
    s_add_u32 s85, s11, 262144
    v_exp_f32 v110, v110
    v_exp_f32 v111, v111
    v_cvt_pk_bf16_f32 v150, v108, v109
    v_cvt_pk_bf16_f32 v151, v110, v111
    s_waitcnt vmcnt(29)
    v_mfma_f32_32x32x16_bf16 v[96:111], a[8:11], v[56:59], 0
    v_exp_f32 v112, v112
    v_exp_f32 v113, v113
    v_exp_f32 v114, v114
    v_mfma_f32_32x32x16_bf16 v[208:223], a[188:191], v[148:151], v[208:223]
    v_exp_f32 v115, v115
    v_cvt_pk_bf16_f32 v152, v112, v113
    v_exp_f32 v116, v116
    v_cvt_pk_bf16_f32 v153, v114, v115
    v_exp_f32 v117, v117
    v_exp_f32 v118, v118
    v_cvt_pk_bf16_f32 v154, v116, v117
    s_add_u32 m0, s71, 0x20000
    s_nop 0
    buffer_load_dwordx4 v172, s[48:51], s85 offen offset:0 lds
    buffer_load_dwordx4 v173, s[48:51], s85 offen offset:1024 lds
    v_exp_f32 v119, v119
    v_exp_f32 v120, v120
    v_cvt_pk_bf16_f32 v155, v118, v119
    v_exp_f32 v121, v121
    v_exp_f32 v122, v122
    v_mfma_f32_32x32x16_bf16 v[224:239], a[40:43], v[152:155], v[224:239]
    v_exp_f32 v123, v123
    v_cvt_pk_bf16_f32 v156, v120, v121
    v_exp_f32 v124, v124
    v_exp_f32 v125, v125
    v_cvt_pk_bf16_f32 v157, v122, v123
    buffer_load_dwordx4 v174, s[48:51], s85 offen offset:2048 lds
    v_exp_f32 v126, v126
    v_exp_f32 v127, v127
    v_cvt_pk_bf16_f32 v158, v124, v125
    v_cvt_pk_bf16_f32 v159, v126, v127
    v_pk_mul_f32 v[138:139], v[192:193], v[192:193]
    v_med3_f32 v136, v200, v165, v166
    v_pk_fma_f32 v[138:139], v[194:195], v[194:195], v[138:139]
    v_pk_fma_f32 v[138:139], v[196:197], v[196:197], v[138:139]
    v_pk_fma_f32 v[138:139], v[198:199], v[198:199], v[138:139]
    v_cmp_eq_f32 s[92:93], v136, v200
    v_add_f32 v138, v138, v139
    v_rcp_f32 v136, v200
    v_med3_f32 v139, v138, v167, v168
    v_cmp_eq_f32 vcc, v139, v138
    s_nop 1
    s_and_b64 vcc, vcc, s[92:93]
    s_cmp_eq_u64 vcc, -1
    s_cbranch_scc0 L_fb_17
L_back_16:
    v_pk_mul_f32 v[192:193], v[192:193], v[136:137] op_sel_hi:[1,0]
    v_pk_mul_f32 v[194:195], v[194:195], v[136:137] op_sel_hi:[1,0]
    v_pk_mul_f32 v[196:197], v[196:197], v[136:137] op_sel_hi:[1,0]
    v_pk_mul_f32 v[198:199], v[198:199], v[136:137] op_sel_hi:[1,0]
    v_cvt_pk_bf16_f32 v128, v192, v193
    v_cvt_pk_bf16_f32 v129, v194, v195
    v_cvt_pk_bf16_f32 v130, v196, v197
    v_cvt_pk_bf16_f32 v131, v198, v199
    buffer_store_dwordx4 v[128:131], v1, s[32:35], s16 offen sc1
    v_pk_mul_f32 v[138:139], v[208:209], v[208:209]
    v_med3_f32 v136, v216, v165, v166
    v_pk_fma_f32 v[138:139], v[210:211], v[210:211], v[138:139]
    v_pk_fma_f32 v[138:139], v[212:213], v[212:213], v[138:139]
    v_pk_fma_f32 v[138:139], v[214:215], v[214:215], v[138:139]
    v_cmp_eq_f32 s[92:93], v136, v216
    v_add_f32 v138, v138, v139
    v_rcp_f32 v136, v216
    v_med3_f32 v139, v138, v167, v168
    v_cmp_eq_f32 vcc, v139, v138
    s_nop 1
    s_and_b64 vcc, vcc, s[92:93]
    s_cmp_eq_u64 vcc, -1
    s_cbranch_scc0 L_fb_19
L_back_18:
    v_pk_mul_f32 v[208:209], v[208:209], v[136:137] op_sel_hi:[1,0]
    v_pk_mul_f32 v[210:211], v[210:211], v[136:137] op_sel_hi:[1,0]
    v_pk_mul_f32 v[212:213], v[212:213], v[136:137] op_sel_hi:[1,0]
    v_pk_mul_f32 v[214:215], v[214:215], v[136:137] op_sel_hi:[1,0]
    v_cvt_pk_bf16_f32 v132, v208, v209
    v_cvt_pk_bf16_f32 v133, v210, v211
    v_cvt_pk_bf16_f32 v134, v212, v213
    v_cvt_pk_bf16_f32 v135, v214, v215
    buffer_store_dwordx4 v[132:135], v1, s[32:35], s17 offen sc1
    v_mfma_f32_32x32x16_bf16 v[112:127], a[8:11], v[60:63], v[80:95]
    v_exp_f32 v96, v96
    v_exp_f32 v97, v97
    v_exp_f32 v98, v98
    v_mfma_f32_32x32x16_bf16 v[224:239], a[44:47], v[156:159], v[224:239]
    v_exp_f32 v99, v99
    v_cvt_pk_bf16_f32 v144, v96, v97
    v_exp_f32 v100, v100
    v_cvt_pk_bf16_f32 v145, v98, v99
    v_exp_f32 v101, v101
    v_exp_f32 v102, v102
    v_cvt_pk_bf16_f32 v146, v100, v101
    buffer_load_dwordx4 v175, s[48:51], s85 offen offset:3072 lds
    s_add_u32 s85, s11, 393216
    s_add_u32 m0, s71, 0x24000
    v_exp_f32 v103, v103
    v_exp_f32 v104, v104
    v_cvt_pk_bf16_f32 v147, v102, v103
    v_exp_f32 v105, v105
    v_exp_f32 v106, v106
    v_mfma_f32_32x32x16_bf16 v[224:239], a[48:51], v[144:147], v[224:239]
    v_exp_f32 v107, v107
    v_cvt_pk_bf16_f32 v148, v104, v105
    v_exp_f32 v108, v108
    v_exp_f32 v109, v109
    v_cvt_pk_bf16_f32 v149, v106, v107
    buffer_load_dwordx4 v172, s[48:51], s85 offen offset:0 lds
    v_exp_f32 v110, v110
    v_exp_f32 v111, v111
    v_cvt_pk_bf16_f32 v150, v108, v109
    v_cvt_pk_bf16_f32 v151, v110, v111
    s_waitcnt vmcnt(33)
    v_mfma_f32_32x32x16_bf16 v[96:111], a[12:15], v[56:59], 0
    v_exp_f32 v112, v112
    v_exp_f32 v113, v113
    v_exp_f32 v114, v114
    v_mfma_f32_32x32x16_bf16 v[224:239], a[52:55], v[148:151], v[224:239]
    v_exp_f32 v115, v115
    v_cvt_pk_bf16_f32 v152, v112, v113
    v_exp_f32 v116, v116
    v_cvt_pk_bf16_f32 v153, v114, v115
    v_exp_f32 v117, v117
    v_exp_f32 v118, v118
    v_cvt_pk_bf16_f32 v154, v116, v117
    buffer_load_dwordx4 v173, s[48:51], s85 offen offset:1024 lds
    buffer_load_dwordx4 v174, s[48:51], s85 offen offset:2048 lds
    v_exp_f32 v119, v119
    v_exp_f32 v120, v120
    v_cvt_pk_bf16_f32 v155, v118, v119
    v_exp_f32 v121, v121
    v_exp_f32 v122, v122
    v_mfma_f32_32x32x16_bf16 v[240:255], a[48:51], v[152:155], v[240:255]
    v_exp_f32 v123, v123
    v_cvt_pk_bf16_f32 v156, v120, v121
    v_exp_f32 v124, v124
    v_exp_f32 v125, v125
    v_cvt_pk_bf16_f32 v157, v122, v123
    buffer_load_dwordx4 v175, s[48:51], s85 offen offset:3072 lds
    s_add_u32 s85, s11, 131072
    v_exp_f32 v126, v126
    v_exp_f32 v127, v127
    v_cvt_pk_bf16_f32 v158, v124, v125
    v_cvt_pk_bf16_f32 v159, v126, v127
    v_mfma_f32_32x32x16_bf16 v[112:127], a[12:15], v[60:63], 0
    v_exp_f32 v96, v96
    v_exp_f32 v97, v97
    v_exp_f32 v98, v98
    v_mfma_f32_32x32x16_bf16 v[240:255], a[52:55], v[156:159], v[240:255]
    v_exp_f32 v99, v99
    v_cvt_pk_bf16_f32 v144, v96, v97
    v_exp_f32 v100, v100
    v_cvt_pk_bf16_f32 v145, v98, v99
    v_exp_f32 v101, v101
    v_exp_f32 v102, v102
    v_cvt_pk_bf16_f32 v146, v100, v101
    s_add_u32 m0, s71, 0xc000
    s_nop 0
    buffer_load_dwordx4 v172, s[44:47], s85 offen offset:0 lds
    buffer_load_dwordx4 v173, s[44:47], s85 offen offset:1024 lds
    v_exp_f32 v103, v103
    v_exp_f32 v104, v104
    v_cvt_pk_bf16_f32 v147, v102, v103
    v_exp_f32 v105, v105
    v_exp_f32 v106, v106
    v_mfma_f32_32x32x16_bf16 v[224:239], a[56:59], v[144:147], v[224:239]
    v_exp_f32 v107, v107
    v_cvt_pk_bf16_f32 v148, v104, v105
    v_exp_f32 v108, v108
    v_exp_f32 v109, v109
    v_cvt_pk_bf16_f32 v149, v106, v107
    buffer_load_dwordx4 v174, s[44:47], s85 offen offset:2048 lds
    v_exp_f32 v110, v110
    v_exp_f32 v111, v111
    v_cvt_pk_bf16_f32 v150, v108, v109
    v_cvt_pk_bf16_f32 v151, v110, v111
    s_waitcnt vmcnt(36)
    v_mfma_f32_32x32x16_bf16 v[96:111], a[16:19], v[56:59], 0
    v_exp_f32 v112, v112
    v_exp_f32 v113, v113
    v_exp_f32 v114, v114
    v_mfma_f32_32x32x16_bf16 v[224:239], a[60:63], v[148:151], v[224:239]
    v_exp_f32 v115, v115
    v_cvt_pk_bf16_f32 v152, v112, v113
    v_exp_f32 v116, v116
    v_cvt_pk_bf16_f32 v153, v114, v115
    v_exp_f32 v117, v117
    v_exp_f32 v118, v118
    v_cvt_pk_bf16_f32 v154, v116, v117
    buffer_load_dwordx4 v175, s[44:47], s85 offen offset:3072 lds
    s_add_u32 s85, s11, 262144
    s_add_u32 m0, s71, 0x10000
    v_exp_f32 v119, v119
    v_exp_f32 v120, v120
    v_cvt_pk_bf16_f32 v155, v118, v119
    v_exp_f32 v121, v121
    v_exp_f32 v122, v122
    v_mfma_f32_32x32x16_bf16 v[240:255], a[56:59], v[152:155], v[240:255]
    v_exp_f32 v123, v123
    v_cvt_pk_bf16_f32 v156, v120, v121
    v_exp_f32 v124, v124
    v_exp_f32 v125, v125
    v_cvt_pk_bf16_f32 v157, v122, v123
    buffer_load_dwordx4 v172, s[44:47], s85 offen offset:0 lds
    v_exp_f32 v126, v126
    v_exp_f32 v127, v127
    v_cvt_pk_bf16_f32 v158, v124, v125
    v_cvt_pk_bf16_f32 v159, v126, v127
    v_mfma_f32_32x32x16_bf16 v[112:127], a[16:19], v[60:63], 0
    v_exp_f32 v96, v96
    v_exp_f32 v97, v97
    v_exp_f32 v98, v98
    v_mfma_f32_32x32x16_bf16 v[240:255], a[60:63], v[156:159], v[240:255]
    v_exp_f32 v99, v99
    v_cvt_pk_bf16_f32 v144, v96, v97
    v_exp_f32 v100, v100
    v_cvt_pk_bf16_f32 v145, v98, v99
    v_exp_f32 v101, v101
    v_exp_f32 v102, v102
    v_cvt_pk_bf16_f32 v146, v100, v101
    buffer_load_dwordx4 v173, s[44:47], s85 offen offset:1024 lds
    buffer_load_dwordx4 v174, s[44:47], s85 offen offset:2048 lds
    v_exp_f32 v103, v103
    v_exp_f32 v104, v104
    v_cvt_pk_bf16_f32 v147, v102, v103
    v_exp_f32 v105, v105
    v_exp_f32 v106, v106
    v_mfma_f32_32x32x16_bf16 v[224:239], a[64:67], v[144:147], v[224:239]
    v_exp_f32 v107, v107
    v_cvt_pk_bf16_f32 v148, v104, v105
    v_exp_f32 v108, v108
    v_exp_f32 v109, v109
    v_cvt_pk_bf16_f32 v149, v106, v107
    buffer_load_dwordx4 v175, s[44:47], s85 offen offset:3072 lds
    s_add_u32 s85, s11, 393216
    v_exp_f32 v110, v110
    v_exp_f32 v111, v111
    v_cvt_pk_bf16_f32 v150, v108, v109
    v_cvt_pk_bf16_f32 v151, v110, v111
    s_waitcnt vmcnt(13)
    buffer_store_dword v30, v31, s[32:35], 0 offen offset:128 sc1
    v_mfma_f32_32x32x16_bf16 v[96:111], a[20:23], v[56:59], 0
    v_exp_f32 v112, v112
    v_exp_f32 v113, v113
    v_exp_f32 v114, v114
    v_mfma_f32_32x32x16_bf16 v[224:239], a[68:71], v[148:151], v[224:239]
    v_exp_f32 v115, v115
    v_cvt_pk_bf16_f32 v152, v112, v113
    v_exp_f32 v116, v116
    v_cvt_pk_bf16_f32 v153, v114, v115
    v_exp_f32 v117, v117
    v_exp_f32 v118, v118
    v_cvt_pk_bf16_f32 v154, v116, v117
    s_add_u32 m0, s71, 0x14000
    s_nop 0
    buffer_load_dwordx4 v172, s[44:47], s85 offen offset:0 lds
    buffer_load_dwordx4 v173, s[44:47], s85 offen offset:1024 lds
L_stub_6:
    s_cbranch_execz L_warm_back
    v_exp_f32 v119, v119
    v_exp_f32 v120, v120
    v_cvt_pk_bf16_f32 v155, v118, v119
    v_exp_f32 v121, v121
    v_exp_f32 v122, v122
    v_mfma_f32_32x32x16_bf16 v[240:255], a[64:67], v[152:155], v[240:255]
    v_exp_f32 v123, v123
    v_cvt_pk_bf16_f32 v156, v120, v121
    v_exp_f32 v124, v124
    v_exp_f32 v125, v125
    v_cvt_pk_bf16_f32 v157, v122, v123
    buffer_load_dwordx4 v174, s[44:47], s85 offen offset:2048 lds
    v_exp_f32 v126, v126
    v_exp_f32 v127, v127
    v_cvt_pk_bf16_f32 v158, v124, v125
    v_cvt_pk_bf16_f32 v159, v126, v127
    v_mfma_f32_32x32x16_bf16 v[112:127], a[20:23], v[60:63], 0
    v_exp_f32 v96, v96
    v_exp_f32 v97, v97
    v_exp_f32 v98, v98
    v_mfma_f32_32x32x16_bf16 v[240:255], a[68:71], v[156:159], v[240:255]
    v_exp_f32 v99, v99
    v_cvt_pk_bf16_f32 v144, v96, v97
    v_exp_f32 v100, v100
    v_cvt_pk_bf16_f32 v145, v98, v99
    v_exp_f32 v101, v101
    v_exp_f32 v102, v102
    v_cvt_pk_bf16_f32 v146, v100, v101
    buffer_load_dwordx4 v175, s[44:47], s85 offen offset:3072 lds
    v_exp_f32 v103, v103
    v_exp_f32 v104, v104
    v_cvt_pk_bf16_f32 v147, v102, v103
    v_exp_f32 v105, v105
    v_exp_f32 v106, v106
    v_mfma_f32_32x32x16_bf16 v[224:239], a[72:75], v[144:147], v[224:239]
    v_exp_f32 v107, v107
    v_cvt_pk_bf16_f32 v148, v104, v105
    v_exp_f32 v108, v108
    v_exp_f32 v109, v109
    v_cvt_pk_bf16_f32 v149, v106, v107
    v_exp_f32 v110, v110
    v_exp_f32 v111, v111
    v_cvt_pk_bf16_f32 v150, v108, v109
    v_cvt_pk_bf16_f32 v151, v110, v111
    v_mfma_f32_32x32x16_bf16 v[96:111], a[24:27], v[56:59], 0
    v_exp_f32 v112, v112
    v_exp_f32 v113, v113
    v_exp_f32 v114, v114
    v_mfma_f32_32x32x16_bf16 v[224:239], a[76:79], v[148:151], v[224:239]
    v_exp_f32 v115, v115
    v_cvt_pk_bf16_f32 v152, v112, v113
    v_exp_f32 v116, v116
    v_cvt_pk_bf16_f32 v153, v114, v115
    v_exp_f32 v117, v117
    v_exp_f32 v118, v118
    v_cvt_pk_bf16_f32 v154, v116, v117
    v_exp_f32 v119, v119
    v_exp_f32 v120, v120
    v_cvt_pk_bf16_f32 v155, v118, v119
    v_exp_f32 v121, v121
    v_exp_f32 v122, v122
    v_mfma_f32_32x32x16_bf16 v[240:255], a[72:75], v[152:155], v[240:255]
    v_exp_f32 v123, v123
    v_cvt_pk_bf16_f32 v156, v120, v121
    v_exp_f32 v124, v124
    v_exp_f32 v125, v125
    v_cvt_pk_bf16_f32 v157, v122, v123
    v_exp_f32 v126, v126
    v_exp_f32 v127, v127
    v_cvt_pk_bf16_f32 v158, v124, v125
    v_cvt_pk_bf16_f32 v159, v126, v127
    v_mfma_f32_32x32x16_bf16 v[112:127], a[24:27], v[60:63], 0
    v_exp_f32 v96, v96
    v_exp_f32 v97, v97
    v_exp_f32 v98, v98
    v_mfma_f32_32x32x16_bf16 v[240:255], a[76:79], v[156:159], v[240:255]
    v_exp_f32 v99, v99
    v_cvt_pk_bf16_f32 v144, v96, v97
    v_exp_f32 v100, v100
    v_cvt_pk_bf16_f32 v145, v98, v99
    v_exp_f32 v101, v101
    v_exp_f32 v102, v102
    v_cvt_pk_bf16_f32 v146, v100, v101
    v_exp_f32 v103, v103
    v_exp_f32 v104, v104
    v_cvt_pk_bf16_f32 v147, v102, v103
    v_exp_f32 v105, v105
    v_exp_f32 v106, v106
    v_mfma_f32_32x32x16_bf16 v[224:239], a[80:83], v[144:147], v[224:239]
    v_exp_f32 v107, v107
    v_cvt_pk_bf16_f32 v148, v104, v105
    v_exp_f32 v108, v108
    v_exp_f32 v109, v109
    v_cvt_pk_bf16_f32 v149, v106, v107
    v_exp_f32 v110, v110
    v_exp_f32 v111, v111
    v_cvt_pk_bf16_f32 v150, v108, v109
    v_cvt_pk_bf16_f32 v151, v110, v111
    v_mfma_f32_32x32x16_bf16 v[96:111], a[28:31], v[56:59], 0
    v_exp_f32 v112, v112
    v_exp_f32 v113, v113
    v_exp_f32 v114, v114
    v_mfma_f32_32x32x16_bf16 v[224:239], a[84:87], v[148:151], v[224:239]
    v_exp_f32 v115, v115
    v_cvt_pk_bf16_f32 v152, v112, v113
    v_exp_f32 v116, v116
    v_cvt_pk_bf16_f32 v153, v114, v115
    v_exp_f32 v117, v117
    v_exp_f32 v118, v118
    v_cvt_pk_bf16_f32 v154, v116, v117
    v_exp_f32 v119, v119
    v_exp_f32 v120, v120
    v_cvt_pk_bf16_f32 v155, v118, v119
    v_exp_f32 v121, v121
    v_exp_f32 v122, v122
    v_mfma_f32_32x32x16_bf16 v[240:255], a[80:83], v[152:155], v[240:255]
    v_exp_f32 v123, v123
    v_cvt_pk_bf16_f32 v156, v120, v121
    v_exp_f32 v124, v124
    v_exp_f32 v125, v125
    v_cvt_pk_bf16_f32 v157, v122, v123
    v_exp_f32 v126, v126
    v_exp_f32 v127, v127
    v_cvt_pk_bf16_f32 v158, v124, v125
    v_cvt_pk_bf16_f32 v159, v126, v127
    v_mfma_f32_32x32x16_bf16 v[112:127], a[28:31], v[60:63], 0
    v_exp_f32 v96, v96
    v_exp_f32 v97, v97
    v_exp_f32 v98, v98
    v_mfma_f32_32x32x16_bf16 v[240:255], a[84:87], v[156:159], v[240:255]
    v_exp_f32 v99, v99
    v_cvt_pk_bf16_f32 v144, v96, v97
    v_exp_f32 v100, v100
    v_cvt_pk_bf16_f32 v145, v98, v99
    v_exp_f32 v101, v101
    v_exp_f32 v102, v102
    v_cvt_pk_bf16_f32 v146, v100, v101
    v_exp_f32 v103, v103
    v_exp_f32 v104, v104
    v_cvt_pk_bf16_f32 v147, v102, v103
    v_exp_f32 v105, v105
    v_exp_f32 v106, v106
    v_mfma_f32_32x32x16_bf16 v[224:239], a[88:91], v[144:147], v[224:239]
    v_exp_f32 v107, v107
    v_cvt_pk_bf16_f32 v148, v104, v105
    v_exp_f32 v108, v108
    v_exp_f32 v109, v109
    v_cvt_pk_bf16_f32 v149, v106, v107
    v_exp_f32 v110, v110
    v_exp_f32 v111, v111
    v_cvt_pk_bf16_f32 v150, v108, v109
    v_cvt_pk_bf16_f32 v151, v110, v111
    v_exp_f32 v112, v112
    v_exp_f32 v113, v113
    v_exp_f32 v114, v114
    v_mfma_f32_32x32x16_bf16 v[224:239], a[92:95], v[148:151], v[224:239]
    v_exp_f32 v115, v115
    v_cvt_pk_bf16_f32 v152, v112, v113
    v_exp_f32 v116, v116
    v_cvt_pk_bf16_f32 v153, v114, v115
    v_exp_f32 v117, v117
    v_exp_f32 v118, v118
    v_cvt_pk_bf16_f32 v154, v116, v117
    v_exp_f32 v119, v119
    v_exp_f32 v120, v120
    v_cvt_pk_bf16_f32 v155, v118, v119
    v_exp_f32 v121, v121
    v_exp_f32 v122, v122
    v_mfma_f32_32x32x16_bf16 v[240:255], a[88:91], v[152:155], v[240:255]
    v_exp_f32 v123, v123
    v_cvt_pk_bf16_f32 v156, v120, v121
    v_exp_f32 v124, v124
    v_exp_f32 v125, v125
    v_cvt_pk_bf16_f32 v157, v122, v123
    v_exp_f32 v126, v126
    v_exp_f32 v127, v127
    v_cvt_pk_bf16_f32 v158, v124, v125
    v_cvt_pk_bf16_f32 v159, v126, v127
    buffer_load_dword v140, v171, s[32:35], 0 offen sc1
    s_nop 0
    v_mfma_f32_32x32x16_bf16 v[240:255], a[92:95], v[156:159], v[240:255]
    v_pk_mul_f32 v[138:139], v[224:225], v[224:225]
    v_med3_f32 v136, v232, v165, v166
    v_pk_fma_f32 v[138:139], v[226:227], v[226:227], v[138:139]
    v_pk_fma_f32 v[138:139], v[228:229], v[228:229], v[138:139]
    v_pk_fma_f32 v[138:139], v[230:231], v[230:231], v[138:139]
    v_cmp_eq_f32 s[92:93], v136, v232
    v_add_f32 v138, v138, v139
    v_rcp_f32 v136, v232
    v_med3_f32 v139, v138, v167, v168
    v_cmp_eq_f32 vcc, v139, v138
    s_nop 1
    s_and_b64 vcc, vcc, s[92:93]
    s_cmp_eq_u64 vcc, -1
    s_cbranch_scc0 L_fb_21
L_back_20:
    v_pk_mul_f32 v[224:225], v[224:225], v[136:137] op_sel_hi:[1,0]
    v_pk_mul_f32 v[226:227], v[226:227], v[136:137] op_sel_hi:[1,0]
    v_pk_mul_f32 v[228:229], v[228:229], v[136:137] op_sel_hi:[1,0]
    v_pk_mul_f32 v[230:231], v[230:231], v[136:137] op_sel_hi:[1,0]
    v_cvt_pk_bf16_f32 v128, v224, v225
    v_cvt_pk_bf16_f32 v129, v226, v227
    v_cvt_pk_bf16_f32 v130, v228, v229
    v_cvt_pk_bf16_f32 v131, v230, v231
    buffer_store_dwordx4 v[128:131], v1, s[32:35], s18 offen sc1
    v_pk_mul_f32 v[138:139], v[240:241], v[240:241]
    v_med3_f32 v136, v248, v165, v166
    v_pk_fma_f32 v[138:139], v[242:243], v[242:243], v[138:139]
    v_pk_fma_f32 v[138:139], v[244:245], v[244:245], v[138:139]
    v_pk_fma_f32 v[138:139], v[246:247], v[246:247], v[138:139]
    v_cmp_eq_f32 s[92:93], v136, v248
    v_add_f32 v138, v138, v139
    v_rcp_f32 v136, v248
    v_med3_f32 v139, v138, v167, v168
    v_cmp_eq_f32 vcc, v139, v138
    s_nop 1
    s_and_b64 vcc, vcc, s[92:93]
    s_cmp_eq_u64 vcc, -1
    s_cbranch_scc0 L_fb_23
L_back_22:
    v_pk_mul_f32 v[240:241], v[240:241], v[136:137] op_sel_hi:[1,0]
    v_pk_mul_f32 v[242:243], v[242:243], v[136:137] op_sel_hi:[1,0]
    v_pk_mul_f32 v[244:245], v[244:245], v[136:137] op_sel_hi:[1,0]
    v_pk_mul_f32 v[246:247], v[246:247], v[136:137] op_sel_hi:[1,0]
    v_cvt_pk_bf16_f32 v132, v240, v241
    v_cvt_pk_bf16_f32 v133, v242, v243
    v_cvt_pk_bf16_f32 v134, v244, v245
    v_cvt_pk_bf16_f32 v135, v246, v247
    buffer_store_dwordx4 v[132:135], v1, s[32:35], s19 offen sc1
L_p3:
L_stub_7:
    s_cbranch_execz L_warm_back
    buffer_store_dword v30, v31, s[32:35], 0 offen offset:256 sc1
    v_and_b32 v141, v176, v30
    s_waitcnt vmcnt(3)
    v_cmp_ne_u32 vcc, v140, v141
    s_nop 1
    s_cbranch_vccz L_polld_25
    s_mov_b32 s95, 131072
L_poll_24:
    buffer_load_dword v140, v171, s[32:35], 0 offen sc1
    s_waitcnt vmcnt(0)
    v_cmp_ne_u32 vcc, v140, v141
    s_nop 1
    s_cbranch_vccz L_polld_25
    s_sub_u32 s95, s95, 1
    s_cmp_lg_u32 s95, 0
    s_cbranch_scc1 L_poll_24
L_polld_25:
    v_add_u32 v171, 128, v171
    s_mov_b32 s80, s89
    buffer_load_dwordx4 a[96:99], v1, s[32:35], s80 offen offset:0 sc1
    buffer_load_dwordx4 a[100:103], v1, s[32:35], s80 offen offset:2048 sc1
    s_add_u32 s80, s80, 4096
    buffer_load_dwordx4 a[104:107], v1, s[32:35], s80 offen offset:0 sc1
    buffer_load_dwordx4 a[108:111], v1, s[32:35], s80 offen offset:2048 sc1
    s_add_u32 s80, s80, 4096
    buffer_load_dwordx4 a[112:115], v1, s[32:35], s80 offen offset:0 sc1
    buffer_load_dwordx4 a[116:119], v1, s[32:35], s80 offen offset:2048 sc1
    s_add_u32 s80, s80, 4096
    buffer_load_dwordx4 a[120:123], v1, s[32:35], s80 offen offset:0 sc1
    buffer_load_dwordx4 a[124:127], v1, s[32:35], s80 offen offset:2048 sc1
    s_add_u32 s80, s80, 4096
    buffer_load_dwordx4 a[128:131], v1, s[32:35], s80 offen offset:0 sc1
    buffer_load_dwordx4 a[132:135], v1, s[32:35], s80 offen offset:2048 sc1
    s_add_u32 s80, s80, 4096
    buffer_load_dwordx4 a[136:139], v1, s[32:35], s80 offen offset:0 sc1
    buffer_load_dwordx4 a[140:143], v1, s[32:35], s80 offen offset:2048 sc1
    s_add_u32 s80, s80, 4096
    buffer_load_dwordx4 a[144:147], v1, s[32:35], s80 offen offset:0 sc1
    buffer_load_dwordx4 a[148:151], v1, s[32:35], s80 offen offset:2048 sc1
    s_add_u32 s80, s80, 4096
    buffer_load_dwordx4 a[152:155], v1, s[32:35], s80 offen offset:0 sc1
    buffer_load_dwordx4 a[156:159], v1, s[32:35], s80 offen offset:2048 sc1
    s_barrier
    buffer_load_dword v4, v179, s[32:35], 0 offen sc1
    ds_read_b64_tr_b16 v[32:33], v177 offset:0
    ds_read_b64_tr_b16 v[34:35], v177 offset:1024
    ds_read_b64_tr_b16 v[36:37], v178 offset:0
    ds_read_b64_tr_b16 v[38:39], v178 offset:1024
    ds_read_b64_tr_b16 v[40:41], v177 offset:4096
    ds_read_b64_tr_b16 v[42:43], v177 offset:5120
    ds_read_b64_tr_b16 v[44:45], v178 offset:4096
    ds_read_b64_tr_b16 v[46:47], v178 offset:5120
    s_waitcnt vmcnt(16) lgkmcnt(6)
    v_mfma_f32_32x32x16_bf16 v[96:111], v[32:35], a[96:99], 0
    s_waitcnt lgkmcnt(4)
    v_mfma_f32_32x32x16_bf16 v[112:127], v[36:39], a[96:99], 0
    ds_read_b64_tr_b16 v[32:33], v177 offset:8192
    ds_read_b64_tr_b16 v[34:35], v177 offset:9216
    ds_read_b64_tr_b16 v[36:37], v178 offset:8192
    ds_read_b64_tr_b16 v[38:39], v178 offset:9216
    s_waitcnt vmcnt(15) lgkmcnt(6)
    v_mfma_f32_32x32x16_bf16 v[96:111], v[40:43], a[100:103], v[96:111]
    s_waitcnt lgkmcnt(4)
    v_mfma_f32_32x32x16_bf16 v[112:127], v[44:47], a[100:103], v[112:127]
    buffer_load_dword v140, v171, s[32:35], 0 offen sc1
    ds_read_b64_tr_b16 v[40:41], v177 offset:12288
    ds_read_b64_tr_b16 v[42:43], v177 offset:13312
    ds_read_b64_tr_b16 v[44:45], v178 offset:12288
    ds_read_b64_tr_b16 v[46:47], v178 offset:13312
    s_waitcnt vmcnt(15) lgkmcnt(6)
    v_mfma_f32_32x32x16_bf16 v[96:111], v[32:35], a[104:107], v[96:111]
    s_waitcnt lgkmcnt(4)
    v_mfma_f32_32x32x16_bf16 v[112:127], v[36:39], a[104:107], v[112:127]
    ds_read_b64_tr_b16 v[32:33], v177 offset:16384
    ds_read_b64_tr_b16 v[34:35], v177 offset:17408
    ds_read_b64_tr_b16 v[36:37], v178 offset:16384
    ds_read_b64_tr_b16 v[38:39], v178 offset:17408
    s_waitcnt vmcnt(14) lgkmcnt(6)
    v_mfma_f32_32x32x16_bf16 v[96:111], v[40:43], a[108:111], v[96:111]
    s_waitcnt lgkmcnt(4)
    v_mfma_f32_32x32x16_bf16 v[112:127], v[44:47], a[108:111], v[112:127]
    ds_read_b64_tr_b16 v[40:41], v177 offset:20480
    ds_read_b64_tr_b16 v[42:43], v177 offset:21504
    ds_read_b64_tr_b16 v[44:45], v178 offset:20480
    ds_read_b64_tr_b16 v[46:47], v178 offset:21504
    s_waitcnt vmcnt(13) lgkmcnt(6)
    v_mfma_f32_32x32x16_bf16 v[96:111], v[32:35], a[112:115], v[96:111]
    s_waitcnt lgkmcnt(4)
    v_mfma_f32_32x32x16_bf16 v[112:127], v[36:39], a[112:115], v[112:127]
    ds_read_b64_tr_b16 v[32:33], v177 offset:24576
    ds_read_b64_tr_b16 v[34:35], v177 offset:25600
    ds_read_b64_tr_b16 v[36:37], v178 offset:24576
    ds_read_b64_tr_b16 v[38:39], v178 offset:25600
    s_waitcnt vmcnt(12) lgkmcnt(6)
    v_mfma_f32_32x32x16_bf16 v[96:111], v[40:43], a[116:119], v[96:111]
    s_waitcnt lgkmcnt(4)
    v_mfma_f32_32x32x16_bf16 v[112:127], v[44:47], a[116:119], v[112:127]
    ds_read_b64_tr_b16 v[40:41], v177 offset:28672
    ds_read_b64_tr_b16 v[42:43], v177 offset:29696
    ds_read_b64_tr_b16 v[44:45], v178 offset:28672
    ds_read_b64_tr_b16 v[46:47], v178 offset:29696
    s_waitcnt vmcnt(11) lgkmcnt(6)
    v_mfma_f32_32x32x16_bf16 v[96:111], v[32:35], a[120:123], v[96:111]
    s_waitcnt lgkmcnt(4)
    v_mfma_f32_32x32x16_bf16 v[112:127], v[36:39], a[120:123], v[112:127]
    ds_read_b64_tr_b16 v[32:33], v177 offset:32768
    ds_read_b64_tr_b16 v[34:35], v177 offset:33792
    ds_read_b64_tr_b16 v[36:37], v178 offset:32768
    ds_read_b64_tr_b16 v[38:39], v178 offset:33792
    s_waitcnt vmcnt(10) lgkmcnt(6)
    v_mfma_f32_32x32x16_bf16 v[96:111], v[40:43], a[124:127], v[96:111]
    s_waitcnt lgkmcnt(4)
    v_mfma_f32_32x32x16_bf16 v[112:127], v[44:47], a[124:127], v[112:127]
    v_and_b32 v141, v176, v30
    s_waitcnt vmcnt(0)
    v_cmp_ne_u32 vcc, v140, v141
    s_nop 1
    s_cbranch_vccz L_polld_27
    s_mov_b32 s95, 131072
L_poll_26:
    buffer_load_dword v140, v171, s[32:35], 0 offen sc1
    s_waitcnt vmcnt(0)
    v_cmp_ne_u32 vcc, v140, v141
    s_nop 1
    s_cbranch_vccz L_polld_27
    s_sub_u32 s95, s95, 1
    s_cmp_lg_u32 s95, 0
    s_cbranch_scc1 L_poll_26
L_polld_27:
    ds_read_b64_tr_b16 v[40:41], v177 offset:36864
    ds_read_b64_tr_b16 v[42:43], v177 offset:37888
    ds_read_b64_tr_b16 v[44:45], v178 offset:36864
    ds_read_b64_tr_b16 v[46:47], v178 offset:37888
    s_waitcnt lgkmcnt(6)
    v_mfma_f32_32x32x16_bf16 v[96:111], v[32:35], a[128:131], v[96:111]
    s_mov_b32 s80, s89
    buffer_load_dwordx4 v[192:195], v1, s[32:35], s80 offen offset:1024 sc1
    s_waitcnt lgkmcnt(4)
    v_mfma_f32_32x32x16_bf16 v[112:127], v[36:39], a[128:131], v[112:127]
    buffer_load_dwordx4 v[196:199], v1, s[32:35], s80 offen offset:3072 sc1
    s_add_u32 s80, s80, 4096
    ds_read_b64_tr_b16 v[32:33], v177 offset:40960
    ds_read_b64_tr_b16 v[34:35], v177 offset:41984
    ds_read_b64_tr_b16 v[36:37], v178 offset:40960
    ds_read_b64_tr_b16 v[38:39], v178 offset:41984
    s_waitcnt lgkmcnt(6)
    v_mfma_f32_32x32x16_bf16 v[96:111], v[40:43], a[132:135], v[96:111]
    buffer_load_dwordx4 v[200:203], v1, s[32:35], s80 offen offset:1024 sc1
    s_waitcnt lgkmcnt(4)
    v_mfma_f32_32x32x16_bf16 v[112:127], v[44:47], a[132:135], v[112:127]
    buffer_load_dwordx4 v[204:207], v1, s[32:35], s80 offen offset:3072 sc1
    s_add_u32 s80, s80, 4096
    ds_read_b64_tr_b16 v[40:41], v177 offset:45056
    ds_read_b64_tr_b16 v[42:43], v177 offset:46080
    ds_read_b64_tr_b16 v[44:45], v178 offset:45056
    ds_read_b64_tr_b16 v[46:47], v178 offset:46080
    s_waitcnt lgkmcnt(6)
    v_mfma_f32_32x32x16_bf16 v[96:111], v[32:35], a[136:139], v[96:111]
    buffer_load_dwordx4 v[208:211], v1, s[32:35], s80 offen offset:1024 sc1
    s_waitcnt lgkmcnt(4)
    v_mfma_f32_32x32x16_bf16 v[112:127], v[36:39], a[136:139], v[112:127]
    buffer_load_dwordx4 v[212:215], v1, s[32:35], s80 offen offset:3072 sc1
    s_add_u32 s80, s80, 4096
    ds_read_b64_tr_b16 v[32:33], v177 offset:49152
    ds_read_b64_tr_b16 v[34:35], v177 offset:50176
    ds_read_b64_tr_b16 v[36:37], v178 offset:49152
    ds_read_b64_tr_b16 v[38:39], v178 offset:50176
    s_waitcnt lgkmcnt(6)
    v_mfma_f32_32x32x16_bf16 v[96:111], v[40:43], a[140:143], v[96:111]
    buffer_load_dwordx4 v[216:219], v1, s[32:35], s80 offen offset:1024 sc1
    s_waitcnt lgkmcnt(4)
    v_mfma_f32_32x32x16_bf16 v[112:127], v[44:47], a[140:143], v[112:127]
    buffer_load_dwordx4 v[220:223], v1, s[32:35], s80 offen offset:3072 sc1
    s_add_u32 s80, s80, 4096
    ds_read_b64_tr_b16 v[40:41], v177 offset:53248
    ds_read_b64_tr_b16 v[42:43], v177 offset:54272
    ds_read_b64_tr_b16 v[44:45], v178 offset:53248
    ds_read_b64_tr_b16 v[46:47], v178 offset:54272
    s_waitcnt lgkmcnt(6)
    v_mfma_f32_32x32x16_bf16 v[96:111], v[32:35], a[144:147], v[96:111]
    buffer_load_dwordx4 v[224:227], v1, s[32:35], s80 offen offset:1024 sc1
    s_waitcnt lgkmcnt(4)
    v_mfma_f32_32x32x16_bf16 v[112:127], v[36:39], a[144:147], v[112:127]
    buffer_load_dwordx4 v[228:231], v1, s[32:35], s80 offen offset:3072 sc1
    s_add_u32 s80, s80, 4096
    ds_read_b64_tr_b16 v[32:33], v177 offset:57344
    ds_read_b64_tr_b16 v[34:35], v177 offset:58368
    ds_read_b64_tr_b16 v[36:37], v178 offset:57344
    ds_read_b64_tr_b16 v[38:39], v178 offset:58368
    s_waitcnt lgkmcnt(6)
    v_mfma_f32_32x32x16_bf16 v[96:111], v[40:43], a[148:151], v[96:111]
    buffer_load_dwordx4 v[232:235], v1, s[32:35], s80 offen offset:1024 sc1
    s_waitcnt lgkmcnt(4)
    v_mfma_f32_32x32x16_bf16 v[112:127], v[44:47], a[148:151], v[112:127]
    buffer_load_dwordx4 v[236:239], v1, s[32:35], s80 offen offset:3072 sc1
    s_add_u32 s80, s80, 4096
    ds_read_b64_tr_b16 v[40:41], v177 offset:61440
    ds_read_b64_tr_b16 v[42:43], v177 offset:62464
    ds_read_b64_tr_b16 v[44:45], v178 offset:61440
    ds_read_b64_tr_b16 v[46:47], v178 offset:62464
    s_waitcnt lgkmcnt(6)
    v_mfma_f32_32x32x16_bf16 v[96:111], v[32:35], a[152:155], v[96:111]
    buffer_load_dwordx4 v[240:243], v1, s[32:35], s80 offen offset:1024 sc1
    s_waitcnt lgkmcnt(4)
    v_mfma_f32_32x32x16_bf16 v[112:127], v[36:39], a[152:155], v[112:127]
    buffer_load_dwordx4 v[244:247], v1, s[32:35], s80 offen offset:3072 sc1
    s_add_u32 s80, s80, 4096
    ds_read_b64_tr_b16 v[32:33], v177 offset:2048
    ds_read_b64_tr_b16 v[34:35], v177 offset:3072
    ds_read_b64_tr_b16 v[36:37], v178 offset:2048
    ds_read_b64_tr_b16 v[38:39], v178 offset:3072
    s_waitcnt lgkmcnt(6)
    v_mfma_f32_32x32x16_bf16 v[96:111], v[40:43], a[156:159], v[96:111]
    buffer_load_dwordx4 v[248:251], v1, s[32:35], s80 offen offset:1024 sc1
    s_waitcnt lgkmcnt(4)
    v_mfma_f32_32x32x16_bf16 v[112:127], v[44:47], a[156:159], v[112:127]
    buffer_load_dwordx4 v[252:255], v1, s[32:35], s80 offen offset:3072 sc1
    v_mov_b32 v5, 0
    ds_read_b64_tr_b16 v[40:41], v177 offset:6144
    ds_read_b64_tr_b16 v[42:43], v177 offset:7168
    ds_read_b64_tr_b16 v[44:45], v178 offset:6144
    ds_read_b64_tr_b16 v[46:47], v178 offset:7168
    s_waitcnt vmcnt(15) lgkmcnt(6)
    v_mfma_f32_32x32x16_bf16 v[96:111], v[32:35], v[192:195], v[96:111]
    v_max3_u32 v5, v5, v192, v193
    s_waitcnt lgkmcnt(4)
    v_mfma_f32_32x32x16_bf16 v[112:127], v[36:39], v[192:195], v[112:127]
    v_max3_u32 v5, v5, v194, v195
    ds_read_b64_tr_b16 v[32:33], v177 offset:10240
    ds_read_b64_tr_b16 v[34:35], v177 offset:11264
    ds_read_b64_tr_b16 v[36:37], v178 offset:10240
    ds_read_b64_tr_b16 v[38:39], v178 offset:11264
    s_waitcnt vmcnt(14) lgkmcnt(6)
    v_mfma_f32_32x32x16_bf16 v[96:111], v[40:43], v[196:199], v[96:111]
    v_max3_u32 v5, v5, v196, v197
    s_waitcnt lgkmcnt(4)
    v_mfma_f32_32x32x16_bf16 v[112:127], v[44:47], v[196:199], v[112:127]
    v_max3_u32 v5, v5, v198, v199
    ds_read_b64_tr_b16 v[40:41], v177 offset:14336
    ds_read_b64_tr_b16 v[42:43], v177 offset:15360
    ds_read_b64_tr_b16 v[44:45], v178 offset:14336
    ds_read_b64_tr_b16 v[46:47], v178 offset:15360
    s_waitcnt vmcnt(13) lgkmcnt(6)
    v_mfma_f32_32x32x16_bf16 v[96:111], v[32:35], v[200:203], v[96:111]
    v_max3_u32 v5, v5, v200, v201
    s_waitcnt lgkmcnt(4)
    v_mfma_f32_32x32x16_bf16 v[112:127], v[36:39], v[200:203], v[112:127]
    v_max3_u32 v5, v5, v202, v203
    ds_read_b64_tr_b16 v[32:33], v177 offset:18432
    ds_read_b64_tr_b16 v[34:35], v177 offset:19456
    ds_read_b64_tr_b16 v[36:37], v178 offset:18432
    ds_read_b64_tr_b16 v[38:39], v178 offset:19456
    s_waitcnt vmcnt(12) lgkmcnt(6)
    v_mfma_f32_32x32x16_bf16 v[96:111], v[40:43], v[204:207], v[96:111]
    v_max3_u32 v5, v5, v204, v205
    s_waitcnt lgkmcnt(4)
    v_mfma_f32_32x32x16_bf16 v[112:127], v[44:47], v[204:207], v[112:127]
    v_max3_u32 v5, v5, v206, v207
    ds_read_b64_tr_b16 v[40:41], v177 offset:22528
    ds_read_b64_tr_b16 v[42:43], v177 offset:23552
    ds_read_b64_tr_b16 v[44:45], v178 offset:22528
    ds_read_b64_tr_b16 v[46:47], v178 offset:23552
    s_waitcnt vmcnt(11) lgkmcnt(6)
    v_mfma_f32_32x32x16_bf16 v[96:111], v[32:35], v[208:211], v[96:111]
    v_max3_u32 v5, v5, v208, v209
    s_waitcnt lgkmcnt(4)
    v_mfma_f32_32x32x16_bf16 v[112:127], v[36:39], v[208:211], v[112:127]
    v_max3_u32 v5, v5, v210, v211
    ds_read_b64_tr_b16 v[32:33], v177 offset:26624
    ds_read_b64_tr_b16 v[34:35], v177 offset:27648
    ds_read_b64_tr_b16 v[36:37], v178 offset:26624
    ds_read_b64_tr_b16 v[38:39], v178 offset:27648
    s_waitcnt vmcnt(10) lgkmcnt(6)
    v_mfma_f32_32x32x16_bf16 v[96:111], v[40:43], v[212:215], v[96:111]
    v_max3_u32 v5, v5, v212, v213
    s_waitcnt lgkmcnt(4)
    v_mfma_f32_32x32x16_bf16 v[112:127], v[44:47], v[212:215], v[112:127]
    v_max3_u32 v5, v5, v214, v215
    ds_read_b64_tr_b16 v[40:41], v177 offset:30720
    ds_read_b64_tr_b16 v[42:43], v177 offset:31744
    ds_read_b64_tr_b16 v[44:45], v178 offset:30720
    ds_read_b64_tr_b16 v[46:47], v178 offset:31744
    s_waitcnt vmcnt(9) lgkmcnt(6)
    v_mfma_f32_32x32x16_bf16 v[96:111], v[32:35], v[216:219], v[96:111]
    v_max3_u32 v5, v5, v216, v217
    s_waitcnt lgkmcnt(4)
    v_mfma_f32_32x32x16_bf16 v[112:127], v[36:39], v[216:219], v[112:127]
    v_max3_u32 v5, v5, v218, v219
    ds_read_b64_tr_b16 v[32:33], v177 offset:34816
    ds_read_b64_tr_b16 v[34:35], v177 offset:35840
    ds_read_b64_tr_b16 v[36:37], v178 offset:34816
    ds_read_b64_tr_b16 v[38:39], v178 offset:35840
    s_waitcnt vmcnt(8) lgkmcnt(6)
    v_mfma_f32_32x32x16_bf16 v[96:111], v[40:43], v[220:223], v[96:111]
    v_max3_u32 v5, v5, v220, v221
    s_waitcnt lgkmcnt(4)
    v_mfma_f32_32x32x16_bf16 v[112:127], v[44:47], v[220:223], v[112:127]
    v_max3_u32 v5, v5, v222, v223
    ds_read_b64_tr_b16 v[40:41], v177 offset:38912
    ds_read_b64_tr_b16 v[42:43], v177 offset:39936
    ds_read_b64_tr_b16 v[44:45], v178 offset:38912
    ds_read_b64_tr_b16 v[46:47], v178 offset:39936
    s_waitcnt vmcnt(7) lgkmcnt(6)
    v_mfma_f32_32x32x16_bf16 v[96:111], v[32:35], v[224:227], v[96:111]
    v_max3_u32 v5, v5, v224, v225
    s_waitcnt lgkmcnt(4)
    v_mfma_f32_32x32x16_bf16 v[112:127], v[36:39], v[224:227], v[112:127]
    v_max3_u32 v5, v5, v226, v227
    ds_read_b64_tr_b16 v[32:33], v177 offset:43008
    ds_read_b64_tr_b16 v[34:35], v177 offset:44032
    ds_read_b64_tr_b16 v[36:37], v178 offset:43008
    ds_read_b64_tr_b16 v[38:39], v178 offset:44032
    s_waitcnt vmcnt(6) lgkmcnt(6)
    v_mfma_f32_32x32x16_bf16 v[96:111], v[40:43], v[228:231], v[96:111]
    v_max3_u32 v5, v5, v228, v229
    s_waitcnt lgkmcnt(4)
    v_mfma_f32_32x32x16_bf16 v[112:127], v[44:47], v[228:231], v[112:127]
    v_max3_u32 v5, v5, v230, v231
    ds_read_b64_tr_b16 v[40:41], v177 offset:47104
    ds_read_b64_tr_b16 v[42:43], v177 offset:48128
    ds_read_b64_tr_b16 v[44:45], v178 offset:47104
    ds_read_b64_tr_b16 v[46:47], v178 offset:48128
    s_waitcnt vmcnt(5) lgkmcnt(6)
    v_mfma_f32_32x32x16_bf16 v[96:111], v[32:35], v[232:235], v[96:111]
    v_max3_u32 v5, v5, v232, v233
    s_waitcnt lgkmcnt(4)
    v_mfma_f32_32x32x16_bf16 v[112:127], v[36:39], v[232:235], v[112:127]
    v_max3_u32 v5, v5, v234, v235
    ds_read_b64_tr_b16 v[32:33], v177 offset:51200
    ds_read_b64_tr_b16 v[34:35], v177 offset:52224
    ds_read_b64_tr_b16 v[36:37], v178 offset:51200
    ds_read_b64_tr_b16 v[38:39], v178 offset:52224
    s_waitcnt vmcnt(4) lgkmcnt(6)
    v_mfma_f32_32x32x16_bf16 v[96:111], v[40:43], v[236:239], v[96:111]
    v_max3_u32 v5, v5, v236, v237
    s_waitcnt lgkmcnt(4)
    v_mfma_f32_32x32x16_bf16 v[112:127], v[44:47], v[236:239], v[112:127]
    v_max3_u32 v5, v5, v238, v239
    ds_read_b64_tr_b16 v[40:41], v177 offset:55296
    ds_read_b64_tr_b16 v[42:43], v177 offset:56320
    ds_read_b64_tr_b16 v[44:45], v178 offset:55296
    ds_read_b64_tr_b16 v[46:47], v178 offset:56320
    s_waitcnt vmcnt(3) lgkmcnt(6)
    v_mfma_f32_32x32x16_bf16 v[96:111], v[32:35], v[240:243], v[96:111]
    v_max3_u32 v5, v5, v240, v241
    s_waitcnt lgkmcnt(4)
    v_mfma_f32_32x32x16_bf16 v[112:127], v[36:39], v[240:243], v[112:127]
    v_max3_u32 v5, v5, v242, v243
    ds_read_b64_tr_b16 v[32:33], v177 offset:59392
    ds_read_b64_tr_b16 v[34:35], v177 offset:60416
    ds_read_b64_tr_b16 v[36:37], v178 offset:59392
    ds_read_b64_tr_b16 v[38:39], v178 offset:60416
    s_waitcnt vmcnt(2) lgkmcnt(6)
    v_mfma_f32_32x32x16_bf16 v[96:111], v[40:43], v[244:247], v[96:111]
    v_max3_u32 v5, v5, v244, v245
    s_waitcnt lgkmcnt(4)
    v_mfma_f32_32x32x16_bf16 v[112:127], v[44:47], v[244:247], v[112:127]
    v_max3_u32 v5, v5, v246, v247
    ds_read_b64_tr_b16 v[40:41], v177 offset:63488
    ds_read_b64_tr_b16 v[42:43], v177 offset:64512
    ds_read_b64_tr_b16 v[44:45], v178 offset:63488
    ds_read_b64_tr_b16 v[46:47], v178 offset:64512
    s_waitcnt vmcnt(1) lgkmcnt(6)
    v_mfma_f32_32x32x16_bf16 v[96:111], v[32:35], v[248:251], v[96:111]
    v_max3_u32 v5, v5, v248, v249
    s_waitcnt lgkmcnt(4)
    v_mfma_f32_32x32x16_bf16 v[112:127], v[36:39], v[248:251], v[112:127]
    v_max3_u32 v5, v5, v250, v251
    s_waitcnt vmcnt(0) lgkmcnt(2)
    v_mfma_f32_32x32x16_bf16 v[96:111], v[40:43], v[252:255], v[96:111]
    v_max3_u32 v5, v5, v252, v253
    s_waitcnt lgkmcnt(0)
    v_mfma_f32_32x32x16_bf16 v[112:127], v[44:47], v[252:255], v[112:127]
    v_max3_u32 v5, v5, v254, v255
    v_cmp_eq_u32 vcc, -1, v5
    s_nop 1
    s_cbranch_vccnz L_redo_28
L_p3back_29:
    v_xor_b32 v21, 4096, v181
    v_sub_f32 v7, 1.0, v4
    s_cmp_eq_u32 s70, 0
    s_cselect_b64 s[92:93], -1, 0
    v_cndmask_b32 v6, v7, v4, s[92:93]
    v_mov_b32 v7, v6
    s_nop 0
    v_pk_mul_f32 v[112:113], v[112:113], v[6:7]
    v_pk_mul_f32 v[114:115], v[114:115], v[6:7]
    v_pk_mul_f32 v[116:117], v[116:117], v[6:7]
    v_pk_mul_f32 v[118:119], v[118:119], v[6:7]
    v_pk_mul_f32 v[120:121], v[120:121], v[6:7]
    v_pk_mul_f32 v[122:123], v[122:123], v[6:7]
    v_pk_mul_f32 v[124:125], v[124:125], v[6:7]
    v_pk_mul_f32 v[126:127], v[126:127], v[6:7]
    ds_write_b128 v181, v[112:115] offset:0
    ds_write_b128 v181, v[116:119] offset:1024
    ds_write_b128 v181, v[120:123] offset:2048
    ds_write_b128 v181, v[124:127] offset:3072
    s_waitcnt lgkmcnt(0)
    s_barrier
    ds_read_b128 v[128:131], v21 offset:0
L_stub_8:
    s_cbranch_execz L_warm_back
    ds_read_b128 v[132:135], v21 offset:1024
    ds_read_b128 v[136:139], v21 offset:2048
    ds_read_b128 v[140:143], v21 offset:3072
    s_waitcnt lgkmcnt(3)
    v_pk_fma_f32 v[96:97], v[96:97], v[6:7], v[128:129]
    v_pk_fma_f32 v[98:99], v[98:99], v[6:7], v[130:131]
    s_waitcnt lgkmcnt(2)
    v_pk_fma_f32 v[100:101], v[100:101], v[6:7], v[132:133]
    v_pk_fma_f32 v[102:103], v[102:103], v[6:7], v[134:135]
    s_waitcnt lgkmcnt(1)
    v_pk_fma_f32 v[104:105], v[104:105], v[6:7], v[136:137]
    v_pk_fma_f32 v[106:107], v[106:107], v[6:7], v[138:139]
    s_waitcnt lgkmcnt(0)
    v_pk_fma_f32 v[108:109], v[108:109], v[6:7], v[140:141]
    v_pk_fma_f32 v[110:111], v[110:111], v[6:7], v[142:143]
    v_cvt_pk_bf16_f32 v144, v96, v97
    v_cvt_pk_bf16_f32 v145, v98, v99
    v_cvt_pk_bf16_f32 v146, v100, v101
    v_cvt_pk_bf16_f32 v147, v102, v103
    v_cvt_pk_bf16_f32 v148, v104, v105
    v_cvt_pk_bf16_f32 v149, v106, v107
    v_cvt_pk_bf16_f32 v150, v108, v109
    v_cvt_pk_bf16_f32 v151, v110, v111
    buffer_store_dwordx4 v[144:147], v180, s[52:55], 0 offen offset:0
    buffer_store_dwordx4 v[148:151], v180, s[52:55], 0 offen offset:16
    s_waitcnt vmcnt(0) lgkmcnt(0)
    s_endpgm
L_code_end:
L_fb_7:
    v_mov_b32 v44, v48
    v_mov_b32 v45, v49
    v_mov_b32 v46, v50
    v_mov_b32 v47, v51
    s_add_u32 s98, s86, 0
    s_add_u32 s99, s87, 0
    s_call_b64 s[96:97], L_fallback
    s_nop 7
    s_nop 7
    v_mov_b32 v192, v32
    v_mov_b32 v193, v33
    v_mov_b32 v194, v34
    v_mov_b32 v195, v35
    v_mov_b32 v196, v36
    v_mov_b32 v197, v37
    v_mov_b32 v198, v38
    v_mov_b32 v199, v39
    v_mov_b32 v200, v40
    s_nop 1
    v_rcp_f32 v136, v200
    s_nop 1
    s_branch L_back_6
L_fb_9:
    v_mov_b32 v44, v52
    v_mov_b32 v45, v53
    v_mov_b32 v46, v54
    v_mov_b32 v47, v55
    s_add_u32 s98, s86, 0
    s_add_u32 s99, s87, 3
    s_call_b64 s[96:97], L_fallback
    s_nop 7
    s_nop 7
    v_mov_b32 v208, v32
    v_mov_b32 v209, v33
    v_mov_b32 v210, v34
    v_mov_b32 v211, v35
    v_mov_b32 v212, v36
    v_mov_b32 v213, v37
    v_mov_b32 v214, v38
    v_mov_b32 v215, v39
    v_mov_b32 v216, v40
    s_nop 1
    v_rcp_f32 v136, v216
    s_nop 1
    s_branch L_back_8
L_fb_11:
    v_mov_b32 v44, v56
    v_mov_b32 v45, v57
    v_mov_b32 v46, v58
    v_mov_b32 v47, v59
    s_add_u32 s98, s86, 1
    s_add_u32 s99, s87, 0
    s_call_b64 s[96:97], L_fallback
    s_nop 7
    s_nop 7
    v_mov_b32 v224, v32
    v_mov_b32 v225, v33
    v_mov_b32 v226, v34
    v_mov_b32 v227, v35
    v_mov_b32 v228, v36
    v_mov_b32 v229, v37
    v_mov_b32 v230, v38
    v_mov_b32 v231, v39
    v_mov_b32 v232, v40
    s_nop 1
    v_rcp_f32 v136, v232
    s_nop 1
    s_branch L_back_10
L_fb_13:
    v_mov_b32 v44, v60
    v_mov_b32 v45, v61
    v_mov_b32 v46, v62
    v_mov_b32 v47, v63
    s_add_u32 s98, s86, 1
    s_add_u32 s99, s87, 3
    s_call_b64 s[96:97], L_fallback
    s_nop 7
    s_nop 7
    v_mov_b32 v240, v32
    v_mov_b32 v241, v33
    v_mov_b32 v242, v34
    v_mov_b32 v243, v35
    v_mov_b32 v244, v36
    v_mov_b32 v245, v37
    v_mov_b32 v246, v38
    v_mov_b32 v247, v39
    v_mov_b32 v248, v40
    s_nop 1
    v_rcp_f32 v136, v248
    s_nop 1
    s_branch L_back_12
L_fb_17:
    v_mov_b32 v44, v48
    v_mov_b32 v45, v49
    v_mov_b32 v46, v50
    v_mov_b32 v47, v51
    s_add_u32 s98, s86, 0
    s_add_u32 s99, s87, 1
    s_call_b64 s[96:97], L_fallback
    s_nop 7
    s_nop 7
    v_mov_b32 v192, v32
    v_mov_b32 v193, v33
    v_mov_b32 v194, v34
    v_mov_b32 v195, v35
    v_mov_b32 v196, v36
    v_mov_b32 v197, v37
    v_mov_b32 v198, v38
    v_mov_b32 v199, v39
    v_mov_b32 v200, v40
    s_nop 1
    v_rcp_f32 v136, v200
    s_nop 1
    s_branch L_back_16
L_fb_19:
    v_mov_b32 v44, v52
    v_mov_b32 v45, v53
    v_mov_b32 v46, v54
    v_mov_b32 v47, v55
    s_add_u32 s98, s86, 0
    s_add_u32 s99, s87, 2
    s_call_b64 s[96:97], L_fallback
    s_nop 7
    s_nop 7
    v_mov_b32 v208, v32
    v_mov_b32 v209, v33
    v_mov_b32 v210, v34
    v_mov_b32 v211, v35
    v_mov_b32 v212, v36
    v_mov_b32 v213, v37
    v_mov_b32 v214, v38
    v_mov_b32 v215, v39
    v_mov_b32 v216, v40
    s_nop 1
    v_rcp_f32 v136, v216
    s_nop 1
    s_branch L_back_18
L_fb_21:
    v_mov_b32 v44, v56
    v_mov_b32 v45, v57
    v_mov_b32 v46, v58
    v_mov_b32 v47, v59
    s_add_u32 s98, s86, 1
    s_add_u32 s99, s87, 1
    s_call_b64 s[96:97], L_fallback
    s_nop 7
    s_nop 7
    v_mov_b32 v224, v32
    v_mov_b32 v225, v33
    v_mov_b32 v226, v34
    v_mov_b32 v227, v35
    v_mov_b32 v228, v36
    v_mov_b32 v229, v37
    v_mov_b32 v230, v38
    v_mov_b32 v231, v39
    v_mov_b32 v232, v40
    s_nop 1
    v_rcp_f32 v136, v232
    s_nop 1
    s_branch L_back_20
L_fb_23:
    v_mov_b32 v44, v60
    v_mov_b32 v45, v61
    v_mov_b32 v46, v62
    v_mov_b32 v47, v63
    s_add_u32 s98, s86, 1
    s_add_u32 s99, s87, 2
    s_call_b64 s[96:97], L_fallback
    s_nop 7
    s_nop 7
    v_mov_b32 v240, v32
    v_mov_b32 v241, v33
    v_mov_b32 v242, v34
    v_mov_b32 v243, v35
    v_mov_b32 v244, v36
    v_mov_b32 v245, v37
    v_mov_b32 v246, v38
    v_mov_b32 v247, v39
    v_mov_b32 v248, v40
    s_nop 1
    v_rcp_f32 v136, v248
    s_nop 1
    s_branch L_back_22
L_redo_28:
    s_mov_b32 s95, 8192
L_rl_30:
    s_mov_b32 s80, s89
    buffer_load_dwordx4 v[192:195], v1, s[32:35], s80 offen offset:1024 sc1
    buffer_load_dwordx4 v[196:199], v1, s[32:35], s80 offen offset:3072 sc1
    s_add_u32 s80, s80, 4096
    buffer_load_dwordx4 v[200:203], v1, s[32:35], s80 offen offset:1024 sc1
    buffer_load_dwordx4 v[204:207], v1, s[32:35], s80 offen offset:3072 sc1
    s_add_u32 s80, s80, 4096
    buffer_load_dwordx4 v[208:211], v1, s[32:35], s80 offen offset:1024 sc1
    buffer_load_dwordx4 v[212:215], v1, s[32:35], s80 offen offset:3072 sc1
    s_add_u32 s80, s80, 4096
    buffer_load_dwordx4 v[216:219], v1, s[32:35], s80 offen offset:1024 sc1
    buffer_load_dwordx4 v[220:223], v1, s[32:35], s80 offen offset:3072 sc1
    s_add_u32 s80, s80, 4096
    buffer_load_dwordx4 v[224:227], v1, s[32:35], s80 offen offset:1024 sc1
    buffer_load_dwordx4 v[228:231], v1, s[32:35], s80 offen offset:3072 sc1
    s_add_u32 s80, s80, 4096
    buffer_load_dwordx4 v[232:235], v1, s[32:35], s80 offen offset:1024 sc1
    buffer_load_dwordx4 v[236:239], v1, s[32:35], s80 offen offset:3072 sc1
    s_add_u32 s80, s80, 4096
    buffer_load_dwordx4 v[240:243], v1, s[32:35], s80 offen offset:1024 sc1
    buffer_load_dwordx4 v[244:247], v1, s[32:35], s80 offen offset:3072 sc1
    s_add_u32 s80, s80, 4096
    buffer_load_dwordx4 v[248:251], v1, s[32:35], s80 offen offset:1024 sc1
    buffer_load_dwordx4 v[252:255], v1, s[32:35], s80 offen offset:3072 sc1
    s_waitcnt vmcnt(0) lgkmcnt(0)
    v_mov_b32 v5, 0
    v_max3_u32 v5, v5, v192, v193
    v_max3_u32 v5, v5, v194, v195
    v_max3_u32 v5, v5, v196, v197
    v_max3_u32 v5, v5, v198, v199
    v_max3_u32 v5, v5, v200, v201
    v_max3_u32 v5, v5, v202, v203
    v_max3_u32 v5, v5, v204, v205
    v_max3_u32 v5, v5, v206, v207
    v_max3_u32 v5, v5, v208, v209
    v_max3_u32 v5, v5, v210, v211
    v_max3_u32 v5, v5, v212, v213
    v_max3_u32 v5, v5, v214, v215
    v_max3_u32 v5, v5, v216, v217
    v_max3_u32 v5, v5, v218, v219
    v_max3_u32 v5, v5, v220, v221
    v_max3_u32 v5, v5, v222, v223
    v_max3_u32 v5, v5, v224, v225
    v_max3_u32 v5, v5, v226, v227
    v_max3_u32 v5, v5, v228, v229
    v_max3_u32 v5, v5, v230, v231
    v_max3_u32 v5, v5, v232, v233
    v_max3_u32 v5, v5, v234, v235
    v_max3_u32 v5, v5, v236, v237
    v_max3_u32 v5, v5, v238, v239
    v_max3_u32 v5, v5, v240, v241
    v_max3_u32 v5, v5, v242, v243
    v_max3_u32 v5, v5, v244, v245
    v_max3_u32 v5, v5, v246, v247
    v_max3_u32 v5, v5, v248, v249
    v_max3_u32 v5, v5, v250, v251
    v_max3_u32 v5, v5, v252, v253
    v_max3_u32 v5, v5, v254, v255
    v_cmp_eq_u32 vcc, -1, v5
    s_nop 1
    s_cbranch_vccz L_rd_31
    s_sub_u32 s95, s95, 1
    s_cmp_lg_u32 s95, 0
    s_cbranch_scc1 L_rl_30
L_rd_31:
    s_nop 7
    s_nop 7
    ds_read_b64_tr_b16 v[32:33], v177 offset:0
    ds_read_b64_tr_b16 v[34:35], v177 offset:1024
    ds_read_b64_tr_b16 v[36:37], v178 offset:0
    ds_read_b64_tr_b16 v[38:39], v178 offset:1024
    ds_read_b64_tr_b16 v[40:41], v177 offset:4096
    ds_read_b64_tr_b16 v[42:43], v177 offset:5120
    ds_read_b64_tr_b16 v[44:45], v178 offset:4096
    ds_read_b64_tr_b16 v[46:47], v178 offset:5120
    s_waitcnt lgkmcnt(6)
    v_mfma_f32_32x32x16_bf16 v[96:111], v[32:35], a[96:99], 0
    s_waitcnt lgkmcnt(4)
    v_mfma_f32_32x32x16_bf16 v[112:127], v[36:39], a[96:99], 0
    ds_read_b64_tr_b16 v[32:33], v177 offset:8192
    ds_read_b64_tr_b16 v[34:35], v177 offset:9216
    ds_read_b64_tr_b16 v[36:37], v178 offset:8192
    ds_read_b64_tr_b16 v[38:39], v178 offset:9216
    s_waitcnt lgkmcnt(6)
    v_mfma_f32_32x32x16_bf16 v[96:111], v[40:43], a[100:103], v[96:111]
    s_waitcnt lgkmcnt(4)
    v_mfma_f32_32x32x16_bf16 v[112:127], v[44:47], a[100:103], v[112:127]
    ds_read_b64_tr_b16 v[40:41], v177 offset:12288
    ds_read_b64_tr_b16 v[42:43], v177 offset:13312
    ds_read_b64_tr_b16 v[44:45], v178 offset:12288
    ds_read_b64_tr_b16 v[46:47], v178 offset:13312
    s_waitcnt lgkmcnt(6)
    v_mfma_f32_32x32x16_bf16 v[96:111], v[32:35], a[104:107], v[96:111]
    s_waitcnt lgkmcnt(4)
    v_mfma_f32_32x32x16_bf16 v[112:127], v[36:39], a[104:107], v[112:127]
    ds_read_b64_tr_b16 v[32:33], v177 offset:16384
    ds_read_b64_tr_b16 v[34:35], v177 offset:17408
    ds_read_b64_tr_b16 v[36:37], v178 offset:16384
    ds_read_b64_tr_b16 v[38:39], v178 offset:17408
    s_waitcnt lgkmcnt(6)
    v_mfma_f32_32x32x16_bf16 v[96:111], v[40:43], a[108:111], v[96:111]
    s_waitcnt lgkmcnt(4)
    v_mfma_f32_32x32x16_bf16 v[112:127], v[44:47], a[108:111], v[112:127]
    ds_read_b64_tr_b16 v[40:41], v177 offset:20480
    ds_read_b64_tr_b16 v[42:43], v177 offset:21504
    ds_read_b64_tr_b16 v[44:45], v178 offset:20480
    ds_read_b64_tr_b16 v[46:47], v178 offset:21504
    s_waitcnt lgkmcnt(6)
    v_mfma_f32_32x32x16_bf16 v[96:111], v[32:35], a[112:115], v[96:111]
    s_waitcnt lgkmcnt(4)
    v_mfma_f32_32x32x16_bf16 v[112:127], v[36:39], a[112:115], v[112:127]
    ds_read_b64_tr_b16 v[32:33], v177 offset:24576
    ds_read_b64_tr_b16 v[34:35], v177 offset:25600
    ds_read_b64_tr_b16 v[36:37], v178 offset:24576
    ds_read_b64_tr_b16 v[38:39], v178 offset:25600
    s_waitcnt lgkmcnt(6)
    v_mfma_f32_32x32x16_bf16 v[96:111], v[40:43], a[116:119], v[96:111]
    s_waitcnt lgkmcnt(4)
    v_mfma_f32_32x32x16_bf16 v[112:127], v[44:47], a[116:119], v[112:127]
    ds_read_b64_tr_b16 v[40:41], v177 offset:28672
    ds_read_b64_tr_b16 v[42:43], v177 offset:29696
    ds_read_b64_tr_b16 v[44:45], v178 offset:28672
    ds_read_b64_tr_b16 v[46:47], v178 offset:29696
    s_waitcnt lgkmcnt(6)
    v_mfma_f32_32x32x16_bf16 v[96:111], v[32:35], a[120:123], v[96:111]
    s_waitcnt lgkmcnt(4)
    v_mfma_f32_32x32x16_bf16 v[112:127], v[36:39], a[120:123], v[112:127]
    ds_read_b64_tr_b16 v[32:33], v177 offset:32768
    ds_read_b64_tr_b16 v[34:35], v177 offset:33792
    ds_read_b64_tr_b16 v[36:37], v178 offset:32768
    ds_read_b64_tr_b16 v[38:39], v178 offset:33792
    s_waitcnt lgkmcnt(6)
    v_mfma_f32_32x32x16_bf16 v[96:111], v[40:43], a[124:127], v[96:111]
    s_waitcnt lgkmcnt(4)
    v_mfma_f32_32x32x16_bf16 v[112:127], v[44:47], a[124:127], v[112:127]
    ds_read_b64_tr_b16 v[40:41], v177 offset:36864
    ds_read_b64_tr_b16 v[42:43], v177 offset:37888
    ds_read_b64_tr_b16 v[44:45], v178 offset:36864
    ds_read_b64_tr_b16 v[46:47], v178 offset:37888
    s_waitcnt lgkmcnt(6)
    v_mfma_f32_32x32x16_bf16 v[96:111], v[32:35], a[128:131], v[96:111]
    s_waitcnt lgkmcnt(4)
    v_mfma_f32_32x32x16_bf16 v[112:127], v[36:39], a[128:131], v[112:127]
    ds_read_b64_tr_b16 v[32:33], v177 offset:40960
    ds_read_b64_tr_b16 v[34:35], v177 offset:41984
    ds_read_b64_tr_b16 v[36:37], v178 offset:40960
    ds_read_b64_tr_b16 v[38:39], v178 offset:41984
    s_waitcnt lgkmcnt(6)
    v_mfma_f32_32x32x16_bf16 v[96:111], v[40:43], a[132:135], v[96:111]
    s_waitcnt lgkmcnt(4)
    v_mfma_f32_32x32x16_bf16 v[112:127], v[44:47], a[132:135], v[112:127]
    ds_read_b64_tr_b16 v[40:41], v177 offset:45056
    ds_read_b64_tr_b16 v[42:43], v177 offset:46080
    ds_read_b64_tr_b16 v[44:45], v178 offset:45056
    ds_read_b64_tr_b16 v[46:47], v178 offset:46080
    s_waitcnt lgkmcnt(6)
    v_mfma_f32_32x32x16_bf16 v[96:111], v[32:35], a[136:139], v[96:111]
    s_waitcnt lgkmcnt(4)
    v_mfma_f32_32x32x16_bf16 v[112:127], v[36:39], a[136:139], v[112:127]
    ds_read_b64_tr_b16 v[32:33], v177 offset:49152
    ds_read_b64_tr_b16 v[34:35], v177 offset:50176
    ds_read_b64_tr_b16 v[36:37], v178 offset:49152
    ds_read_b64_tr_b16 v[38:39], v178 offset:50176
    s_waitcnt lgkmcnt(6)
    v_mfma_f32_32x32x16_bf16 v[96:111], v[40:43], a[140:143], v[96:111]
    s_waitcnt lgkmcnt(4)
    v_mfma_f32_32x32x16_bf16 v[112:127], v[44:47], a[140:143], v[112:127]
    ds_read_b64_tr_b16 v[40:41], v177 offset:53248
    ds_read_b64_tr_b16 v[42:43], v177 offset:54272
    ds_read_b64_tr_b16 v[44:45], v178 offset:53248
    ds_read_b64_tr_b16 v[46:47], v178 offset:54272
    s_waitcnt lgkmcnt(6)
    v_mfma_f32_32x32x16_bf16 v[96:111], v[32:35], a[144:147], v[96:111]
    s_waitcnt lgkmcnt(4)
    v_mfma_f32_32x32x16_bf16 v[112:127], v[36:39], a[144:147], v[112:127]
    ds_read_b64_tr_b16 v[32:33], v177 offset:57344
    ds_read_b64_tr_b16 v[34:35], v177 offset:58368
    ds_read_b64_tr_b16 v[36:37], v178 offset:57344
    ds_read_b64_tr_b16 v[38:39], v178 offset:58368
    s_waitcnt lgkmcnt(6)
    v_mfma_f32_32x32x16_bf16 v[96:111], v[40:43], a[148:151], v[96:111]
    s_waitcnt lgkmcnt(4)
    v_mfma_f32_32x32x16_bf16 v[112:127], v[44:47], a[148:151], v[112:127]
    ds_read_b64_tr_b16 v[40:41], v177 offset:61440
    ds_read_b64_tr_b16 v[42:43], v177 offset:62464
    ds_read_b64_tr_b16 v[44:45], v178 offset:61440
    ds_read_b64_tr_b16 v[46:47], v178 offset:62464
    s_waitcnt lgkmcnt(6)
    v_mfma_f32_32x32x16_bf16 v[96:111], v[32:35], a[152:155], v[96:111]
    s_waitcnt lgkmcnt(4)
    v_mfma_f32_32x32x16_bf16 v[112:127], v[36:39], a[152:155], v[112:127]
    ds_read_b64_tr_b16 v[32:33], v177 offset:2048
    ds_read_b64_tr_b16 v[34:35], v177 offset:3072
    ds_read_b64_tr_b16 v[36:37], v178 offset:2048
    ds_read_b64_tr_b16 v[38:39], v178 offset:3072
    s_waitcnt lgkmcnt(6)
    v_mfma_f32_32x32x16_bf16 v[96:111], v[40:43], a[156:159], v[96:111]
    s_waitcnt lgkmcnt(4)
    v_mfma_f32_32x32x16_bf16 v[112:127], v[44:47], a[156:159], v[112:127]
    ds_read_b64_tr_b16 v[40:41], v177 offset:6144
    ds_read_b64_tr_b16 v[42:43], v177 offset:7168
    ds_read_b64_tr_b16 v[44:45], v178 offset:6144
    ds_read_b64_tr_b16 v[46:47], v178 offset:7168
    s_waitcnt lgkmcnt(6)
    v_mfma_f32_32x32x16_bf16 v[96:111], v[32:35], v[192:195], v[96:111]
    s_waitcnt lgkmcnt(4)
    v_mfma_f32_32x32x16_bf16 v[112:127], v[36:39], v[192:195], v[112:127]
    ds_read_b64_tr_b16 v[32:33], v177 offset:10240
    ds_read_b64_tr_b16 v[34:35], v177 offset:11264
    ds_read_b64_tr_b16 v[36:37], v178 offset:10240
    ds_read_b64_tr_b16 v[38:39], v178 offset:11264
    s_waitcnt lgkmcnt(6)
    v_mfma_f32_32x32x16_bf16 v[96:111], v[40:43], v[196:199], v[96:111]
    s_waitcnt lgkmcnt(4)
    v_mfma_f32_32x32x16_bf16 v[112:127], v[44:47], v[196:199], v[112:127]
    ds_read_b64_tr_b16 v[40:41], v177 offset:14336
    ds_read_b64_tr_b16 v[42:43], v177 offset:15360
    ds_read_b64_tr_b16 v[44:45], v178 offset:14336
    ds_read_b64_tr_b16 v[46:47], v178 offset:15360
    s_waitcnt lgkmcnt(6)
    v_mfma_f32_32x32x16_bf16 v[96:111], v[32:35], v[200:203], v[96:111]
    s_waitcnt lgkmcnt(4)
    v_mfma_f32_32x32x16_bf16 v[112:127], v[36:39], v[200:203], v[112:127]
    ds_read_b64_tr_b16 v[32:33], v177 offset:18432
    ds_read_b64_tr_b16 v[34:35], v177 offset:19456
    ds_read_b64_tr_b16 v[36:37], v178 offset:18432
    ds_read_b64_tr_b16 v[38:39], v178 offset:19456
    s_waitcnt lgkmcnt(6)
    v_mfma_f32_32x32x16_bf16 v[96:111], v[40:43], v[204:207], v[96:111]
    s_waitcnt lgkmcnt(4)
    v_mfma_f32_32x32x16_bf16 v[112:127], v[44:47], v[204:207], v[112:127]
    ds_read_b64_tr_b16 v[40:41], v177 offset:22528
    ds_read_b64_tr_b16 v[42:43], v177 offset:23552
    ds_read_b64_tr_b16 v[44:45], v178 offset:22528
    ds_read_b64_tr_b16 v[46:47], v178 offset:23552
    s_waitcnt lgkmcnt(6)
    v_mfma_f32_32x32x16_bf16 v[96:111], v[32:35], v[208:211], v[96:111]
    s_waitcnt lgkmcnt(4)
    v_mfma_f32_32x32x16_bf16 v[112:127], v[36:39], v[208:211], v[112:127]
    ds_read_b64_tr_b16 v[32:33], v177 offset:26624
    ds_read_b64_tr_b16 v[34:35], v177 offset:27648
    ds_read_b64_tr_b16 v[36:37], v178 offset:26624
    ds_read_b64_tr_b16 v[38:39], v178 offset:27648
    s_waitcnt lgkmcnt(6)
    v_mfma_f32_32x32x16_bf16 v[96:111], v[40:43], v[212:215], v[96:111]
    s_waitcnt lgkmcnt(4)
    v_mfma_f32_32x32x16_bf16 v[112:127], v[44:47], v[212:215], v[112:127]
    ds_read_b64_tr_b16 v[40:41], v177 offset:30720
    ds_read_b64_tr_b16 v[42:43], v177 offset:31744
    ds_read_b64_tr_b16 v[44:45], v178 offset:30720
    ds_read_b64_tr_b16 v[46:47], v178 offset:31744
    s_waitcnt lgkmcnt(6)
    v_mfma_f32_32x32x16_bf16 v[96:111], v[32:35], v[216:219], v[96:111]
    s_waitcnt lgkmcnt(4)
    v_mfma_f32_32x32x16_bf16 v[112:127], v[36:39], v[216:219], v[112:127]
    ds_read_b64_tr_b16 v[32:33], v177 offset:34816
    ds_read_b64_tr_b16 v[34:35], v177 offset:35840
    ds_read_b64_tr_b16 v[36:37], v178 offset:34816
    ds_read_b64_tr_b16 v[38:39], v178 offset:35840
    s_waitcnt lgkmcnt(6)
    v_mfma_f32_32x32x16_bf16 v[96:111], v[40:43], v[220:223], v[96:111]
    s_waitcnt lgkmcnt(4)
    v_mfma_f32_32x32x16_bf16 v[112:127], v[44:47], v[220:223], v[112:127]
    ds_read_b64_tr_b16 v[40:41], v177 offset:38912
    ds_read_b64_tr_b16 v[42:43], v177 offset:39936
    ds_read_b64_tr_b16 v[44:45], v178 offset:38912
    ds_read_b64_tr_b16 v[46:47], v178 offset:39936
    s_waitcnt lgkmcnt(6)
    v_mfma_f32_32x32x16_bf16 v[96:111], v[32:35], v[224:227], v[96:111]
    s_waitcnt lgkmcnt(4)
    v_mfma_f32_32x32x16_bf16 v[112:127], v[36:39], v[224:227], v[112:127]
    ds_read_b64_tr_b16 v[32:33], v177 offset:43008
    ds_read_b64_tr_b16 v[34:35], v177 offset:44032
    ds_read_b64_tr_b16 v[36:37], v178 offset:43008
    ds_read_b64_tr_b16 v[38:39], v178 offset:44032
    s_waitcnt lgkmcnt(6)
    v_mfma_f32_32x32x16_bf16 v[96:111], v[40:43], v[228:231], v[96:111]
    s_waitcnt lgkmcnt(4)
    v_mfma_f32_32x32x16_bf16 v[112:127], v[44:47], v[228:231], v[112:127]
    ds_read_b64_tr_b16 v[40:41], v177 offset:47104
    ds_read_b64_tr_b16 v[42:43], v177 offset:48128
    ds_read_b64_tr_b16 v[44:45], v178 offset:47104
    ds_read_b64_tr_b16 v[46:47], v178 offset:48128
    s_waitcnt lgkmcnt(6)
    v_mfma_f32_32x32x16_bf16 v[96:111], v[32:35], v[232:235], v[96:111]
    s_waitcnt lgkmcnt(4)
    v_mfma_f32_32x32x16_bf16 v[112:127], v[36:39], v[232:235], v[112:127]
    ds_read_b64_tr_b16 v[32:33], v177 offset:51200
    ds_read_b64_tr_b16 v[34:35], v177 offset:52224
    ds_read_b64_tr_b16 v[36:37], v178 offset:51200
    ds_read_b64_tr_b16 v[38:39], v178 offset:52224
    s_waitcnt lgkmcnt(6)
    v_mfma_f32_32x32x16_bf16 v[96:111], v[40:43], v[236:239], v[96:111]
    s_waitcnt lgkmcnt(4)
    v_mfma_f32_32x32x16_bf16 v[112:127], v[44:47], v[236:239], v[112:127]
    ds_read_b64_tr_b16 v[40:41], v177 offset:55296
    ds_read_b64_tr_b16 v[42:43], v177 offset:56320
    ds_read_b64_tr_b16 v[44:45], v178 offset:55296
    ds_read_b64_tr_b16 v[46:47], v178 offset:56320
    s_waitcnt lgkmcnt(6)
    v_mfma_f32_32x32x16_bf16 v[96:111], v[32:35], v[240:243], v[96:111]
    s_waitcnt lgkmcnt(4)
    v_mfma_f32_32x32x16_bf16 v[112:127], v[36:39], v[240:243], v[112:127]
    ds_read_b64_tr_b16 v[32:33], v177 offset:59392
    ds_read_b64_tr_b16 v[34:35], v177 offset:60416
    ds_read_b64_tr_b16 v[36:37], v178 offset:59392
    ds_read_b64_tr_b16 v[38:39], v178 offset:60416
    s_waitcnt lgkmcnt(6)
    v_mfma_f32_32x32x16_bf16 v[96:111], v[40:43], v[244:247], v[96:111]
    s_waitcnt lgkmcnt(4)
    v_mfma_f32_32x32x16_bf16 v[112:127], v[44:47], v[244:247], v[112:127]
    ds_read_b64_tr_b16 v[40:41], v177 offset:63488
    ds_read_b64_tr_b16 v[42:43], v177 offset:64512
    ds_read_b64_tr_b16 v[44:45], v178 offset:63488
    ds_read_b64_tr_b16 v[46:47], v178 offset:64512
    s_waitcnt lgkmcnt(6)
    v_mfma_f32_32x32x16_bf16 v[96:111], v[32:35], v[248:251], v[96:111]
    s_waitcnt lgkmcnt(4)
    v_mfma_f32_32x32x16_bf16 v[112:127], v[36:39], v[248:251], v[112:127]
    s_waitcnt lgkmcnt(2)
    v_mfma_f32_32x32x16_bf16 v[96:111], v[40:43], v[252:255], v[96:111]
    s_waitcnt lgkmcnt(0)
    v_mfma_f32_32x32x16_bf16 v[112:127], v[44:47], v[252:255], v[112:127]
    s_nop 7
    s_nop 7
    s_branch L_p3back_29
L_fallback:
    v_accvgpr_write_b32 a192, v160
    v_accvgpr_write_b32 a193, v161
    v_accvgpr_write_b32 a194, v162
    v_accvgpr_write_b32 a195, v163
    v_accvgpr_write_b32 a196, v164
    v_accvgpr_write_b32 a197, v165
    v_accvgpr_write_b32 a198, v166
    v_accvgpr_write_b32 a199, v167
    v_accvgpr_write_b32 a200, v168
    v_accvgpr_write_b32 a201, v169
    v_accvgpr_write_b32 a202, v170
    v_accvgpr_write_b32 a203, v171
    v_accvgpr_write_b32 a204, v172
    v_accvgpr_write_b32 a205, v173
    v_accvgpr_write_b32 a206, v174
    v_accvgpr_write_b32 a207, v175
    v_accvgpr_write_b32 a208, v176
    v_accvgpr_write_b32 a209, v177
    v_accvgpr_write_b32 a210, v178
    v_accvgpr_write_b32 a211, v179
    v_accvgpr_write_b32 a212, v180
    v_accvgpr_write_b32 a213, v181
    v_accvgpr_write_b32 a214, v182
    v_accvgpr_write_b32 a215, v183
    v_accvgpr_write_b32 a216, v184
    v_accvgpr_write_b32 a217, v185
    v_accvgpr_write_b32 a218, v186
    v_accvgpr_write_b32 a219, v187
    v_accvgpr_write_b32 a220, v188
    v_accvgpr_write_b32 a221, v189
    v_accvgpr_write_b32 a222, v190
    v_accvgpr_write_b32 a223, v191
    v_bfe_u32 v20, v0, 0, 1
    v_lshlrev_b32 v20, 3, v20
    s_lshl_b32 s76, s70, 2
    s_add_u32 s76, s76, s88
    v_add_u32 v20, s76, v20
    v_cmp_gt_u32 vcc, 2, v0
    v_mov_b32 v21, 0x7f000000
    v_mov_b32 v22, 0
    v_cndmask_b32 v23, v22, -1, vcc
    v_cndmask_b32 v20, v21, v20, vcc
    v_mov_b32 v142, v160
    v_mov_b32 v143, v161
    v_and_b32 v23, v23, v30
    s_mov_b32 s95, 131072
L_fbp_32:
    buffer_load_dword v22, v20, s[32:35], 0 offen sc1
    s_waitcnt vmcnt(0)
    v_cmp_ne_u32 vcc, v22, v23
    s_nop 1
    s_cbranch_vccz L_fbpd_33
    s_sub_u32 s95, s95, 1
    s_cmp_lg_u32 s95, 0
    s_cbranch_scc1 L_fbp_32
L_fbpd_33:
    v_mov_b32 v139, 0xff800000
    s_mov_b32 s100, 0
L_fbl_34:
    s_add_u32 s76, s99, s100
    s_cmp_lt_u32 s76, 8
    s_cbranch_scc1 L_fbn_35
    s_sub_u32 s76, s76, 8
    s_lshl_b32 s77, s98, 16
    s_lshl_b32 s78, s76, 10
    s_add_u32 s77, s77, s78
    buffer_load_dwordx4 v[40:43], v1, s[32:35], s77 offen sc1
    s_waitcnt vmcnt(0)
    s_cmp_eq_u32 s100, 0
    s_cbranch_scc1 L_fbf_36
    s_cmp_eq_u32 s100, 8
    s_cbranch_scc1 L_fbd_37
    v_mfma_f32_32x32x16_bf16 v[160:175], v[40:43], v[44:47], 0
    s_branch L_fbj_38
L_fbf_36:
    s_nop 10
    v_mfma_f32_32x32x16_bf16 v[160:175], v[40:43], v[44:47], v[80:95]
    s_branch L_fbj_38
L_fbd_37:
    s_nop 10
    v_mfma_f32_32x32x16_bf16 v[160:175], v[40:43], v[44:47], v[64:79]
L_fbj_38:
    s_nop 15
    s_nop 3
    v_max3_f32 v139, v139, v160, v161
    v_max3_f32 v139, v139, v162, v163
    v_max3_f32 v139, v139, v164, v165
    v_max3_f32 v139, v139, v166, v167
    v_max3_f32 v139, v139, v168, v169
    v_max3_f32 v139, v139, v170, v171
    v_max3_f32 v139, v139, v172, v173
    v_max3_f32 v139, v139, v174, v175
L_fbn_35:
    s_add_u32 s100, s100, 1
    s_cmp_le_u32 s100, 8
    s_cbranch_scc1 L_fbl_34
    v_mov_b32 v138, v139
    s_nop 1
    v_permlane32_swap_b32 v138, v139
    s_nop 1
    v_max_f32 v139, v139, v138
    v_mov_b32 v176, 0
    v_mov_b32 v177, 0
    v_mov_b32 v178, 0
    v_mov_b32 v179, 0
    v_mov_b32 v180, 0
    v_mov_b32 v181, 0
    v_mov_b32 v182, 0
    v_mov_b32 v183, 0
    v_mov_b32 v184, 0
    v_mov_b32 v185, 0
    v_mov_b32 v186, 0
    v_mov_b32 v187, 0
    v_mov_b32 v188, 0
    v_mov_b32 v189, 0
    v_mov_b32 v190, 0
    v_mov_b32 v191, 0
    s_mov_b32 s100, 0
L_fbl_39:
    s_add_u32 s76, s99, s100
    s_cmp_lt_u32 s76, 8
    s_cbranch_scc1 L_fbn_40
    s_sub_u32 s76, s76, 8
    s_lshl_b32 s77, s98, 16
    s_lshl_b32 s78, s76, 10
    s_add_u32 s77, s77, s78
    buffer_load_dwordx4 v[40:43], v1, s[32:35], s77 offen sc1
    s_mul_i32 s77, s98, 73728
    s_mul_i32 s78, s76, 1152
    s_add_u32 s77, s77, s78
    s_add_u32 s77, s77, 0x400000
    buffer_load_dwordx4 v[32:35], v142, s[32:35], s77 offen offset:0 sc1
    buffer_load_dwordx4 v[36:39], v143, s[32:35], s77 offen offset:0 sc1
    s_waitcnt vmcnt(0)
    s_cmp_eq_u32 s100, 0
    s_cbranch_scc1 L_fbf_41
    s_cmp_eq_u32 s100, 8
    s_cbranch_scc1 L_fbd_42
    v_mfma_f32_32x32x16_bf16 v[160:175], v[40:43], v[44:47], 0
    s_branch L_fbj_43
L_fbf_41:
    s_nop 10
    v_mfma_f32_32x32x16_bf16 v[160:175], v[40:43], v[44:47], v[80:95]
    s_branch L_fbj_43
L_fbd_42:
    s_nop 10
    v_mfma_f32_32x32x16_bf16 v[160:175], v[40:43], v[44:47], v[64:79]
L_fbj_43:
    s_nop 15
    s_nop 3
    v_sub_f32 v160, v160, v139
    v_sub_f32 v161, v161, v139
    v_sub_f32 v162, v162, v139
    v_sub_f32 v163, v163, v139
    v_sub_f32 v164, v164, v139
    v_sub_f32 v165, v165, v139
    v_sub_f32 v166, v166, v139
    v_sub_f32 v167, v167, v139
    v_sub_f32 v168, v168, v139
    v_sub_f32 v169, v169, v139
    v_sub_f32 v170, v170, v139
    v_sub_f32 v171, v171, v139
    v_sub_f32 v172, v172, v139
    v_sub_f32 v173, v173, v139
    v_sub_f32 v174, v174, v139
    v_sub_f32 v175, v175, v139
    v_exp_f32 v160, v160
    v_exp_f32 v161, v161
    v_exp_f32 v162, v162
    v_exp_f32 v163, v163
    v_exp_f32 v164, v164
    v_exp_f32 v165, v165
    v_exp_f32 v166, v166
    v_exp_f32 v167, v167
    v_exp_f32 v168, v168
    v_exp_f32 v169, v169
    v_exp_f32 v170, v170
    v_exp_f32 v171, v171
    v_exp_f32 v172, v172
    v_exp_f32 v173, v173
    v_exp_f32 v174, v174
    v_exp_f32 v175, v175
    s_nop 1
    v_cvt_pk_bf16_f32 v128, v160, v161
    v_cvt_pk_bf16_f32 v129, v162, v163
    v_cvt_pk_bf16_f32 v130, v164, v165
    v_cvt_pk_bf16_f32 v131, v166, v167
    v_cvt_pk_bf16_f32 v132, v168, v169
    v_cvt_pk_bf16_f32 v133, v170, v171
    v_cvt_pk_bf16_f32 v134, v172, v173
    v_cvt_pk_bf16_f32 v135, v174, v175
    s_nop 1
    v_mfma_f32_32x32x16_bf16 v[176:191], v[32:35], v[128:131], v[176:191]
    v_mfma_f32_32x32x16_bf16 v[176:191], v[36:39], v[132:135], v[176:191]
    s_nop 15
    s_nop 3
L_fbn_40:
    s_add_u32 s100, s100, 1
    s_cmp_le_u32 s100, 8
    s_cbranch_scc1 L_fbl_39
    v_mov_b32 v32, v176
    v_mov_b32 v33, v177
    v_mov_b32 v34, v178
    v_mov_b32 v35, v179
    v_mov_b32 v36, v180
    v_mov_b32 v37, v181
    v_mov_b32 v38, v182
    v_mov_b32 v39, v183
    v_mov_b32 v40, v184
    v_accvgpr_read_b32 v160, a192
    v_accvgpr_read_b32 v161, a193
    v_accvgpr_read_b32 v162, a194
    v_accvgpr_read_b32 v163, a195
    v_accvgpr_read_b32 v164, a196
    v_accvgpr_read_b32 v165, a197
    v_accvgpr_read_b32 v166, a198
    v_accvgpr_read_b32 v167, a199
    v_accvgpr_read_b32 v168, a200
    v_accvgpr_read_b32 v169, a201
    v_accvgpr_read_b32 v170, a202
    v_accvgpr_read_b32 v171, a203
    v_accvgpr_read_b32 v172, a204
    v_accvgpr_read_b32 v173, a205
    v_accvgpr_read_b32 v174, a206
    v_accvgpr_read_b32 v175, a207
    v_accvgpr_read_b32 v176, a208
    v_accvgpr_read_b32 v177, a209
    v_accvgpr_read_b32 v178, a210
    v_accvgpr_read_b32 v179, a211
    v_accvgpr_read_b32 v180, a212
    v_accvgpr_read_b32 v181, a213
    v_accvgpr_read_b32 v182, a214
    v_accvgpr_read_b32 v183, a215
    v_accvgpr_read_b32 v184, a216
    v_accvgpr_read_b32 v185, a217
    v_accvgpr_read_b32 v186, a218
    v_accvgpr_read_b32 v187, a219
    v_accvgpr_read_b32 v188, a220
    v_accvgpr_read_b32 v189, a221
    v_accvgpr_read_b32 v190, a222
    v_accvgpr_read_b32 v191, a223
    s_setpc_b64 s[96:97]
L_end:
    s_endpgm

.section .rodata,"a"
.p2align 6
.amdhsa_kernel gated_mix__sliding_block__sliding_block__prompt_kernel
  .amdhsa_next_free_vgpr 512
  .amdhsa_next_free_sgpr 102
  .amdhsa_accum_offset 256
  .amdhsa_group_segment_fixed_size 0
  .amdhsa_kernarg_size 80
  .amdhsa_user_sgpr_count 2
  .amdhsa_user_sgpr_kernarg_segment_ptr 1
  .amdhsa_system_sgpr_workgroup_id_x 1
  .amdhsa_float_denorm_mode_32 3
.end_amdhsa_kernel
```
